```python
import torch

def _softmax(x, axis=-1):
    return torch.softmax(x, dim=axis)
def _gelu(x):
    return torch.nn.functional.gelu(x, approximate="tanh")
def _silu(x):
    return torch.nn.functional.silu(x)
def _sigmoid(x):
    return torch.sigmoid(x)
def _layernorm(x, axis=-1, eps=1e-5):
    m = x.mean(dim=axis, keepdim=True)
    v = x.var(dim=axis, keepdim=True, unbiased=False)
    return (x - m) / torch.sqrt(v + eps)
def _scatter_add(tgt, idx, src, axis=0):
    return tgt.clone().index_add_(axis, idx, src)
def _segment_sum(src, seg, n):
    out = torch.zeros((n,) + src.shape[1:], dtype=src.dtype)
    return out.index_add_(0, seg, src)
def _pad(x, pw):
    flat = tuple(v for pair in reversed(pw) for v in pair)
    return torch.nn.functional.pad(x, flat)

kernel_name = 'standalone__mha_block_cached__near_ridge'

def setup_inputs():

    _w = (lambda a: (lambda t: t.to(torch.bfloat16) if t.is_floating_point() else t)(torch.as_tensor(a)))
    B, Sq, D = 8, 112, 512
    H, Sk, Dh = 32, 1024, 128
    return {
        "x": _w((lambda *s: torch.randn(*s, dtype=torch.bfloat16) * 0.8)(B, Sq, D)),
        "k_cache": _w((lambda *s: torch.randn(*s, dtype=torch.bfloat16) * 0.8)(B, H, Sk, Dh)),
        "v_cache": _w((lambda *s: torch.randn(*s, dtype=torch.bfloat16) * 0.05)(B, H, Sk, Dh)),
        "wq": _w((lambda *s: torch.randn(*s, dtype=torch.bfloat16) * 0.8)(D, H * Dh) * (D ** -0.5)),
        "wo": _w((lambda *s: torch.randn(*s, dtype=torch.bfloat16) * 0.05)(H * Dh, D) * ((H * Dh) ** -0.5)),
    }

def reference(x, k_cache, v_cache, wq, wo):
    B, Sq, D = x.shape
    H, Dh = 32, 128
    q = (lambda x, *d: x.permute(*d))((x @ wq).reshape(B, Sq, H, Dh), 0, 2, 1, 3)
    scores = torch.einsum("bhqd,bhkd->bhqk", q, k_cache) * (Dh ** -0.5)
    p = _softmax(scores, axis=-1)
    o = torch.einsum("bhqk,bhkd->bhqd", p, v_cache)
    return (lambda x, *d: x.permute(*d))(o, 0, 2, 1, 3).reshape(B, Sq, H * Dh) @ wo
```

```asm
; @launch grid=(256,1,1) block=(512,1,1) lds=163840
.amdgcn_target "amdgcn-amd-amdhsa--gfx950"
.text
.globl standalone__mha_block_cached__near_ridge_kernel
.p2align 8
.type standalone__mha_block_cached__near_ridge_kernel,@function
standalone__mha_block_cached__near_ridge_kernel:
L_start:
    s_cmp_ge_u32 s2, 256
    s_cbranch_scc1 L_end
    s_load_dwordx16 s[4:19], s[0:1], 0
    v_lshrrev_b32 v1, 6, v0
    v_and_b32 v0, 63, v0
    v_readfirstlane_b32 s20, v1
    s_and_b32 s21, s2, 7
    s_lshr_b32 s22, s2, 5
    s_lshr_b32 s23, s2, 3
    s_and_b32 s23, s23, 3
    s_lshl_b32 s24, s21, 2
    s_add_u32 s24, s24, s23
    s_lshl_b32 s25, s22, 5
    s_add_u32 s25, s25, s24
    s_cmp_lt_u32 s20, 4
    s_cbranch_scc1 L_compute
    v_lshrrev_b32 v1, 4, v0
    v_and_b32 v3, 15, v0
    s_cmp_lt_u32 s20, 6
    s_cbranch_scc1 L_ldkv
    s_setprio 2
    s_cmp_eq_u32 s20, 7
    s_cbranch_scc1 L_setw
    v_lshrrev_b32 v5, 3, v0
    v_and_b32 v6, 7, v0
    v_lshrrev_b32 v7, 1, v5
    v_xor_b32 v4, v7, v6
    v_lshlrev_b32 v4, 4, v4
    v_lshl_add_u32 v10, v5, 10, v4
    v_xor_b32 v4, 64, v10
    v_add_u32 v11, 7168, v4
    v_add_u32 v12, 14336, v10
    v_add_u32 v13, 21504, v4
    s_mul_i32 s43, s22, 114688
    s_mov_b32 s30, 114688
    s_mov_b32 s54, 32768
    s_mov_b32 s55, 7
    s_mov_b32 s56, 98304
    s_waitcnt lgkmcnt(0)
    s_add_u32 s28, s4, s43
    s_addc_u32 s29, s5, 0
    s_branch L_setj
L_setw:
    v_lshlrev_b32 v4, 1, v1
    v_xor_b32 v4, v4, v3
    v_lshlrev_b32 v4, 4, v4
    v_lshl_add_u32 v10, v1, 13, v4
    v_add_u32 v11, 31744, v10
    v_xor_b32 v4, 128, v10
    v_add_u32 v12, 63488, v4
    v_add_u32 v13, 95232, v4
    s_lshl_b32 s43, s24, 8
    s_sub_u32 s30, 0x400000, s43
    s_mov_b32 s54, 131072
    s_mov_b32 s55, 19
    s_mov_b32 s56, 114688
    s_waitcnt lgkmcnt(0)
    s_add_u32 s28, s10, s43
    s_addc_u32 s29, s11, 0
L_setj:
    s_mov_b32 s31, 0x20000
    s_lshl_b32 s45, s23, 1
    s_add_u32 s45, s45, s22
    s_and_b32 s45, s45, 3
    s_movk_i32 s59, 0x1000
    s_add_u32 s57, s56, 32768
    s_sub_u32 s58, s56, 65536
    s_mov_b32 s42, 8
    s_branch L_xwgo
L_xw:
    s_waitcnt vmcnt(16)
    s_barrier
L_xwgo:
    s_lshl_b32 s40, s45, s55
    s_mov_b32 m0, s56
    s_add_u32 s45, s45, 1
    s_and_b32 s45, s45, 7
    s_mov_b32 s53, -4
L_xwg:
    buffer_load_dwordx4 v10, s[28:31], s40 offen  lds
    buffer_load_dwordx4 v11, s[28:31], s40 offen offset:1024  lds
    buffer_load_dwordx4 v12, s[28:31], s40 offen offset:2048  lds
    buffer_load_dwordx4 v13, s[28:31], s40 offen offset:3072  lds
    s_add_u32 m0, m0, s59
    s_add_u32 s40, s40, s54
    s_add_u32 s53, s53, 1
    s_cbranch_scc0 L_xwg
    s_mov_b32 s53, s56
    s_mov_b32 s56, s57
    s_mov_b32 s57, s58
    s_mov_b32 s58, s53
    s_sub_u32 s42, s42, 1
    s_cmp_eq_u32 s42, 7
    s_cbranch_scc1 L_xwgo
    s_cmp_lg_u32 s42, 0
    s_cbranch_scc1 L_xw
    s_barrier
    v_lshlrev_b32 v2, 2, v1
    v_xor_b32 v2, v2, v3
    v_lshlrev_b32 v2, 4, v2
    v_lshl_add_u32 v14, v1, 10, v2
    v_add_u32 v15, 3072, v14
    v_add_u32 v16, 6144, v14
    v_add_u32 v17, 9216, v14
    s_lshl_b32 s43, s21, 19
    s_lshl_b32 s44, s23, 8
    s_add_u32 s43, s43, s44
    s_sub_u32 s44, 0x400000, s43
    s_add_u32 s32, s12, s43
    s_addc_u32 s33, s13, 0
    s_mov_b32 s34, s44
    s_mov_b32 s35, 0x20000
    s_waitcnt vmcnt(16)
    s_barrier
    s_waitcnt vmcnt(0)
    s_barrier
    s_barrier
    s_setprio 0
    s_cmp_eq_u32 s20, 7
    s_cbranch_scc1 L_attw
    s_barrier
    s_barrier
    s_barrier
    s_barrier
    s_barrier
    s_xor_b32 s40, s23, 0
    s_lshl_b32 s40, s40, 17
    s_mov_b32 s41, 98304
    s_mov_b32 s42, 4
L_x2:
    s_mov_b32 m0, s41
    s_add_u32 s43, s41, 4096
    buffer_load_dwordx4 v14, s[32:35], s40 offen  lds
    buffer_load_dwordx4 v15, s[32:35], s40 offen offset:1024  lds
    buffer_load_dwordx4 v16, s[32:35], s40 offen offset:2048  lds
    buffer_load_dwordx4 v17, s[32:35], s40 offen offset:3072  lds
    s_mov_b32 m0, s43
    s_add_u32 s40, s40, 16384
    buffer_load_dwordx4 v14, s[32:35], s40 offen  lds
    buffer_load_dwordx4 v15, s[32:35], s40 offen offset:1024  lds
    buffer_load_dwordx4 v16, s[32:35], s40 offen offset:2048  lds
    buffer_load_dwordx4 v17, s[32:35], s40 offen offset:3072  lds
    s_add_u32 s40, s40, 16384
    s_add_u32 s41, s41, 8192
    s_barrier
    s_barrier
    s_barrier
    s_barrier
    s_sub_u32 s42, s42, 1
    s_cmp_lg_u32 s42, 0
    s_cbranch_scc1 L_x2
    s_xor_b32 s40, s23, 2
    s_lshl_b32 s40, s40, 17
    s_add_u32 s40, s40, 0
    s_mov_b32 s41, 32768
    s_mov_b32 m0, s41
    s_add_u32 s43, s41, 4096
    buffer_load_dwordx4 v14, s[32:35], s40 offen  lds
    buffer_load_dwordx4 v15, s[32:35], s40 offen offset:1024  lds
    buffer_load_dwordx4 v16, s[32:35], s40 offen offset:2048  lds
    buffer_load_dwordx4 v17, s[32:35], s40 offen offset:3072  lds
    s_mov_b32 m0, s43
    s_add_u32 s40, s40, 16384
    buffer_load_dwordx4 v14, s[32:35], s40 offen  lds
    buffer_load_dwordx4 v15, s[32:35], s40 offen offset:1024  lds
    buffer_load_dwordx4 v16, s[32:35], s40 offen offset:2048  lds
    buffer_load_dwordx4 v17, s[32:35], s40 offen offset:3072  lds
    s_add_u32 s40, s40, 16384
    s_add_u32 s41, s41, 8192
    s_barrier
    s_barrier
    s_barrier
    s_barrier
    s_mov_b32 m0, s41
    s_add_u32 s43, s41, 4096
    buffer_load_dwordx4 v14, s[32:35], s40 offen  lds
    buffer_load_dwordx4 v15, s[32:35], s40 offen offset:1024  lds
    buffer_load_dwordx4 v16, s[32:35], s40 offen offset:2048  lds
    buffer_load_dwordx4 v17, s[32:35], s40 offen offset:3072  lds
    s_mov_b32 m0, s43
    s_add_u32 s40, s40, 16384
    buffer_load_dwordx4 v14, s[32:35], s40 offen  lds
    buffer_load_dwordx4 v15, s[32:35], s40 offen offset:1024  lds
    buffer_load_dwordx4 v16, s[32:35], s40 offen offset:2048  lds
    buffer_load_dwordx4 v17, s[32:35], s40 offen offset:3072  lds
    s_add_u32 s40, s40, 16384
    s_barrier
    s_barrier
    s_barrier
    s_barrier
    s_barrier
    s_waitcnt vmcnt(0)
    s_barrier
    s_barrier
    s_barrier
    s_endpgm
L_attw:
    s_barrier
    s_barrier
    s_barrier
    s_lshl_b32 s43, s22, 5
    s_add_u32 s36, s16, s43
    s_addc_u32 s37, s17, 0
    s_load_dword s38, s[36:37], 0x0 glc
    s_xor_b32 s40, s23, 1
    s_lshl_b32 s40, s40, 17
    s_mov_b32 s41, 131072
    s_mov_b32 s42, 4
L_w2:
    s_mov_b32 m0, s41
    s_add_u32 s43, s41, 4096
    buffer_load_dwordx4 v14, s[32:35], s40 offen  lds
    buffer_load_dwordx4 v15, s[32:35], s40 offen offset:1024  lds
    buffer_load_dwordx4 v16, s[32:35], s40 offen offset:2048  lds
    buffer_load_dwordx4 v17, s[32:35], s40 offen offset:3072  lds
    s_mov_b32 m0, s43
    s_add_u32 s40, s40, 16384
    buffer_load_dwordx4 v14, s[32:35], s40 offen  lds
    buffer_load_dwordx4 v15, s[32:35], s40 offen offset:1024  lds
    buffer_load_dwordx4 v16, s[32:35], s40 offen offset:2048  lds
    buffer_load_dwordx4 v17, s[32:35], s40 offen offset:3072  lds
    s_add_u32 s40, s40, 16384
    s_add_u32 s41, s41, 8192
    s_barrier
    s_barrier
    s_barrier
    s_barrier
    s_sub_u32 s42, s42, 1
    s_cmp_lg_u32 s42, 0
    s_cbranch_scc1 L_w2
    s_xor_b32 s40, s23, 2
    s_lshl_b32 s40, s40, 17
    s_add_u32 s40, s40, 65536
    s_mov_b32 s41, 49152
    s_mov_b32 m0, s41
    s_add_u32 s43, s41, 4096
    buffer_load_dwordx4 v14, s[32:35], s40 offen  lds
    buffer_load_dwordx4 v15, s[32:35], s40 offen offset:1024  lds
    buffer_load_dwordx4 v16, s[32:35], s40 offen offset:2048  lds
    buffer_load_dwordx4 v17, s[32:35], s40 offen offset:3072  lds
    s_mov_b32 m0, s43
    s_add_u32 s40, s40, 16384
    buffer_load_dwordx4 v14, s[32:35], s40 offen  lds
    buffer_load_dwordx4 v15, s[32:35], s40 offen offset:1024  lds
    buffer_load_dwordx4 v16, s[32:35], s40 offen offset:2048  lds
    buffer_load_dwordx4 v17, s[32:35], s40 offen offset:3072  lds
    s_add_u32 s40, s40, 16384
    s_add_u32 s41, s41, 8192
    s_barrier
    s_barrier
    s_barrier
    s_barrier
    s_mov_b32 m0, s41
    s_add_u32 s43, s41, 4096
    buffer_load_dwordx4 v14, s[32:35], s40 offen  lds
    buffer_load_dwordx4 v15, s[32:35], s40 offen offset:1024  lds
    buffer_load_dwordx4 v16, s[32:35], s40 offen offset:2048  lds
    buffer_load_dwordx4 v17, s[32:35], s40 offen offset:3072  lds
    s_mov_b32 m0, s43
    s_add_u32 s40, s40, 16384
    buffer_load_dwordx4 v14, s[32:35], s40 offen  lds
    buffer_load_dwordx4 v15, s[32:35], s40 offen offset:1024  lds
    buffer_load_dwordx4 v16, s[32:35], s40 offen offset:2048  lds
    buffer_load_dwordx4 v17, s[32:35], s40 offen offset:3072  lds
    s_add_u32 s40, s40, 16384
    s_barrier
    s_barrier
    s_barrier
    s_mov_b32 s42, 0x100000
    s_branch L_wchk
L_wpoll:
    s_load_dword s38, s[36:37], 0x0 glc
L_wchk:
    s_waitcnt lgkmcnt(0)
    s_sub_u32 s42, s42, 1
    s_cbranch_scc1 L_wpolld
    s_cmp_lt_u32 s38, 32
    s_cbranch_scc1 L_wpoll
L_wpolld:
    s_barrier
    s_barrier
    s_barrier
    s_barrier
    s_waitcnt vmcnt(0)
    s_barrier
    s_barrier
    s_barrier
    s_endpgm
    .p2align 8
L_ldkv:
    s_cmp_eq_u32 s20, 5
    s_cbranch_scc1 L_ldv
    v_add_u32 v4, 0, v1
    v_xor_b32 v4, v4, v3
    v_lshlrev_b32 v4, 4, v4
    v_lshl_add_u32 v10, v1, 8, v4
    v_add_u32 v4, 4, v1
    v_xor_b32 v4, v4, v3
    v_lshlrev_b32 v4, 4, v4
    v_lshl_add_u32 v11, v1, 8, v4
    v_add_u32 v4, 8, v1
    v_xor_b32 v4, v4, v3
    v_lshlrev_b32 v4, 4, v4
    v_lshl_add_u32 v12, v1, 8, v4
    v_add_u32 v4, 12, v1
    v_xor_b32 v4, v4, v3
    v_lshlrev_b32 v4, 4, v4
    v_lshl_add_u32 v13, v1, 8, v4
    s_lshl_b32 s43, s25, 18
    s_waitcnt lgkmcnt(0)
    s_add_u32 s28, s6, s43
    s_addc_u32 s29, s7, 0
    s_mov_b32 s30, 0x40000
    s_mov_b32 s31, 0x20000
    s_mov_b32 s40, 0
    s_mov_b32 s41, 0
    s_mov_b32 s26, 0
    s_mov_b32 s27, 49152
    s_lshl_b32 s43, s21, 19
    s_lshr_b32 s44, s2, 3
    s_lshl_b32 s44, s44, 14
    s_add_u32 s43, s43, s44
    s_add_u32 s36, s12, s43
    s_addc_u32 s37, s13, 0
    s_mov_b32 s38, 16384
    s_mov_b32 s39, 0x20000
    v_lshlrev_b32 v18, 7, v0
    v_add_u32 v19, 8192, v18
    s_mov_b32 m0, s41
    s_add_u32 s43, s41, 4096
    buffer_load_dwordx4 v10, s[28:31], s40 offen nt lds
    buffer_load_dwordx4 v11, s[28:31], s40 offen offset:1024 nt lds
    buffer_load_dwordx4 v12, s[28:31], s40 offen offset:2048 nt lds
    buffer_load_dwordx4 v13, s[28:31], s40 offen offset:3072 nt lds
    s_mov_b32 m0, s43
    s_add_u32 s40, s40, 4096
    buffer_load_dwordx4 v10, s[28:31], s40 offen nt lds
    buffer_load_dwordx4 v11, s[28:31], s40 offen offset:1024 nt lds
    buffer_load_dwordx4 v12, s[28:31], s40 offen offset:2048 nt lds
    buffer_load_dwordx4 v13, s[28:31], s40 offen offset:3072 nt lds
    s_add_u32 s40, s40, 4096
    s_add_u32 s41, s41, 8192
    s_cmp_eq_u32 s41, s27
    s_cselect_b32 s41, s26, s41
    s_barrier
    buffer_load_dword v20, v18, s[36:39], 0 offen
    buffer_load_dword v21, v19, s[36:39], 0 offen
    v_lshlrev_b32 v2, 2, v1
    v_xor_b32 v2, v2, v3
    v_lshlrev_b32 v2, 4, v2
    v_lshl_add_u32 v14, v1, 10, v2
    v_add_u32 v15, 3072, v14
    v_add_u32 v16, 6144, v14
    v_add_u32 v17, 9216, v14
    s_lshl_b32 s43, s21, 19
    s_lshl_b32 s44, s23, 8
    s_add_u32 s43, s43, s44
    s_sub_u32 s44, 0x400000, s43
    s_add_u32 s32, s12, s43
    s_addc_u32 s33, s13, 0
    s_mov_b32 s34, s44
    s_mov_b32 s35, 0x20000
    s_mov_b32 s42, 6
L_ke:
    s_barrier
    s_sub_u32 s42, s42, 1
    s_cmp_lg_u32 s42, 0
    s_cbranch_scc1 L_ke
    s_mov_b32 s53, 2
L_kq5:
    s_mov_b32 m0, s41
    s_add_u32 s43, s41, 4096
    buffer_load_dwordx4 v10, s[28:31], s40 offen nt lds
    buffer_load_dwordx4 v11, s[28:31], s40 offen offset:1024 nt lds
    buffer_load_dwordx4 v12, s[28:31], s40 offen offset:2048 nt lds
    buffer_load_dwordx4 v13, s[28:31], s40 offen offset:3072 nt lds
    s_mov_b32 m0, s43
    s_add_u32 s40, s40, 4096
    buffer_load_dwordx4 v10, s[28:31], s40 offen nt lds
    buffer_load_dwordx4 v11, s[28:31], s40 offen offset:1024 nt lds
    buffer_load_dwordx4 v12, s[28:31], s40 offen offset:2048 nt lds
    buffer_load_dwordx4 v13, s[28:31], s40 offen offset:3072 nt lds
    s_add_u32 s40, s40, 4096
    s_add_u32 s41, s41, 8192
    s_cmp_eq_u32 s41, s27
    s_cselect_b32 s41, s26, s41
    s_sub_u32 s53, s53, 1
    s_cmp_lg_u32 s53, 0
    s_cbranch_scc1 L_kq5
    s_mov_b32 s42, -3
    s_mov_b32 s54, 3
L_kd:
    s_sub_u32 s55, s54, s42
    s_cmp_eq_u32 s55, 4
    s_cbranch_scc1 L_kd1
    s_cmp_eq_u32 s55, 5
    s_cbranch_scc1 L_kd2
    s_cmp_eq_u32 s55, 6
    s_cbranch_scc1 L_kd3
    s_cmp_eq_u32 s55, 7
    s_cbranch_scc1 L_kd4
    s_cmp_ge_u32 s55, 8
    s_cbranch_scc1 L_kd5
    s_waitcnt vmcnt(0)
L_kd1:
    s_waitcnt vmcnt(8)
L_kd2:
    s_waitcnt vmcnt(16)
L_kd3:
    s_waitcnt vmcnt(24)
L_kd4:
    s_waitcnt vmcnt(32)
L_kd5:
    s_waitcnt vmcnt(40)
    s_barrier
    s_getreg_b32 s55, hwreg(HW_REG_IB_STS, 22, 2)
    s_getreg_b32 s56, hwreg(HW_REG_IB_STS, 0, 4)
    s_lshl_b32 s55, s55, 4
    s_or_b32 s56, s56, s55
L_kdi:
    s_cmp_le_u32 s54, 21
    s_cselect_b32 s57, 7, 5
    s_add_u32 s57, s57, s42
    s_cmp_lt_i32 s42, 0
    s_cselect_b32 s57, 4, s57
    s_min_u32 s57, s57, 35
    s_cmp_gt_u32 s54, s57
    s_cbranch_scc1 L_kdn
    s_cmp_le_u32 s56, 8
    s_cbranch_scc1 L_kdg
    s_add_u32 s57, s42, 3
    s_cmp_gt_i32 s54, s57
    s_cbranch_scc1 L_kdn
L_kdg:
    s_cmp_ge_u32 s54, 32
    s_cbranch_scc1 L_kdw
    s_cmp_eq_u32 s54, 19
    s_cselect_b32 s27, 32768, s27
    s_mov_b32 m0, s41
    s_add_u32 s43, s41, 4096
    buffer_load_dwordx4 v10, s[28:31], s40 offen nt lds
    buffer_load_dwordx4 v11, s[28:31], s40 offen offset:1024 nt lds
    buffer_load_dwordx4 v12, s[28:31], s40 offen offset:2048 nt lds
    buffer_load_dwordx4 v13, s[28:31], s40 offen offset:3072 nt lds
    s_mov_b32 m0, s43
    s_add_u32 s40, s40, 4096
    buffer_load_dwordx4 v10, s[28:31], s40 offen nt lds
    buffer_load_dwordx4 v11, s[28:31], s40 offen offset:1024 nt lds
    buffer_load_dwordx4 v12, s[28:31], s40 offen offset:2048 nt lds
    buffer_load_dwordx4 v13, s[28:31], s40 offen offset:3072 nt lds
    s_add_u32 s40, s40, 4096
    s_add_u32 s41, s41, 8192
    s_cmp_eq_u32 s41, s27
    s_cselect_b32 s41, s26, s41
L_kdj:
    s_add_u32 s54, s54, 1
    s_add_u32 s56, s56, 8
    s_branch L_kdi
L_kdw:
    s_add_u32 s44, s54, 2
    s_and_b32 s44, s44, 3
    s_lshl_b32 s41, s44, 13
    s_xor_b32 s40, s23, 3
    s_lshl_b32 s40, s40, 2
    s_add_u32 s40, s40, s44
    s_lshl_b32 s40, s40, 15
    s_mov_b32 m0, s41
    s_add_u32 s43, s41, 4096
    buffer_load_dwordx4 v14, s[32:35], s40 offen  lds
    buffer_load_dwordx4 v15, s[32:35], s40 offen offset:1024  lds
    buffer_load_dwordx4 v16, s[32:35], s40 offen offset:2048  lds
    buffer_load_dwordx4 v17, s[32:35], s40 offen offset:3072  lds
    s_mov_b32 m0, s43
    s_add_u32 s40, s40, 16384
    buffer_load_dwordx4 v14, s[32:35], s40 offen  lds
    buffer_load_dwordx4 v15, s[32:35], s40 offen offset:1024  lds
    buffer_load_dwordx4 v16, s[32:35], s40 offen offset:2048  lds
    buffer_load_dwordx4 v17, s[32:35], s40 offen offset:3072  lds
    s_add_u32 s40, s40, 16384
    s_branch L_kdj
L_kdn:
    s_add_u32 s42, s42, 1
    s_cmp_lt_i32 s42, 30
    s_cbranch_scc1 L_kd
    s_barrier
L_k2:
    s_add_u32 s44, s54, 2
    s_and_b32 s44, s44, 3
    s_lshl_b32 s41, s44, 13
    s_xor_b32 s40, s23, 3
    s_lshl_b32 s40, s40, 2
    s_add_u32 s40, s40, s44
    s_lshl_b32 s40, s40, 15
    s_mov_b32 m0, s41
    s_add_u32 s43, s41, 4096
    buffer_load_dwordx4 v14, s[32:35], s40 offen  lds
    buffer_load_dwordx4 v15, s[32:35], s40 offen offset:1024  lds
    buffer_load_dwordx4 v16, s[32:35], s40 offen offset:2048  lds
    buffer_load_dwordx4 v17, s[32:35], s40 offen offset:3072  lds
    s_mov_b32 m0, s43
    s_add_u32 s40, s40, 16384
    buffer_load_dwordx4 v14, s[32:35], s40 offen  lds
    buffer_load_dwordx4 v15, s[32:35], s40 offen offset:1024  lds
    buffer_load_dwordx4 v16, s[32:35], s40 offen offset:2048  lds
    buffer_load_dwordx4 v17, s[32:35], s40 offen offset:3072  lds
    s_add_u32 s40, s40, 16384
    s_add_u32 s54, s54, 1
    s_cmp_le_u32 s54, 35
    s_cbranch_scc1 L_k2
    s_barrier
    s_waitcnt vmcnt(0)
    s_barrier
    s_endpgm
    .p2align 8
L_ldv:
    v_lshlrev_b32 v4, 1, v1
    v_xor_b32 v4, v4, v3
    v_lshlrev_b32 v4, 4, v4
    v_lshl_add_u32 v10, v1, 8, v4
    v_lshlrev_b32 v4, 1, v1
    v_xor_b32 v4, v4, v3
    v_xor_b32 v4, 8, v4
    v_lshlrev_b32 v4, 4, v4
    v_lshl_add_u32 v11, v1, 8, v4
    s_lshl_b32 s43, s25, 18
    s_waitcnt lgkmcnt(0)
    s_add_u32 s28, s8, s43
    s_addc_u32 s29, s9, 0
    s_mov_b32 s30, 0x40000
    s_mov_b32 s31, 0x20000
    s_mov_b32 s40, 0
    s_mov_b32 s41, 65536
    s_mov_b32 s26, 49152
    s_mov_b32 s27, 98304
    s_mov_b32 s36, s18
    s_mov_b32 s37, s19
    s_mov_b32 s38, 0x10000000
    s_mov_b32 s39, 0x20000
    v_mov_b32 v4, 0
    v_mov_b32 v5, 0
    s_lshl_b32 s43, s25, 11
    v_lshlrev_b32 v8, 3, v0
    buffer_store_dwordx2 v[4:5], v8, s[36:39], s43 offen sc1
    buffer_store_dwordx2 v[4:5], v8, s[36:39], s43 offen offset:1024 sc1
    s_getreg_b32 s44, hwreg(HW_REG_XCC_ID, 0, 4)
    s_add_u32 s44, s44, 1
    v_mov_b32 v7, s44
    s_mov_b64 exec, 1
    buffer_store_dword v7, v4, s[36:39], s43 offen offset:512 sc1
    s_mov_b64 exec, -1
    s_lshl_b32 s43, s22, 5
    s_add_u32 s32, s16, s43
    s_addc_u32 s33, s17, 0
    s_mov_b32 s34, 1
    s_mov_b32 m0, s41
    s_add_u32 s43, s41, 4096
    buffer_load_dwordx4 v10, s[28:31], s40 offen nt lds
    buffer_load_dwordx4 v11, s[28:31], s40 offen offset:1024 nt lds
    buffer_load_dwordx4 v10, s[28:31], s40 offen offset:2048 nt lds
    buffer_load_dwordx4 v11, s[28:31], s40 offen offset:3072 nt lds
    s_mov_b32 m0, s43
    s_add_u32 s40, s40, 4096
    buffer_load_dwordx4 v10, s[28:31], s40 offen nt lds
    buffer_load_dwordx4 v11, s[28:31], s40 offen offset:1024 nt lds
    buffer_load_dwordx4 v10, s[28:31], s40 offen offset:2048 nt lds
    buffer_load_dwordx4 v11, s[28:31], s40 offen offset:3072 nt lds
    s_add_u32 s40, s40, 4096
    s_add_u32 s41, s41, 8192
    s_cmp_eq_u32 s41, s27
    s_cselect_b32 s41, s26, s41
    s_barrier
    s_waitcnt vmcnt(8)
    s_atomic_add s34, s[32:33], 0x0
    s_mov_b32 s42, 6
L_ve:
    s_barrier
    s_sub_u32 s42, s42, 1
    s_cmp_lg_u32 s42, 0
    s_cbranch_scc1 L_ve
    s_mov_b32 s53, 2
L_vq5:
    s_mov_b32 m0, s41
    s_add_u32 s43, s41, 4096
    buffer_load_dwordx4 v10, s[28:31], s40 offen nt lds
    buffer_load_dwordx4 v11, s[28:31], s40 offen offset:1024 nt lds
    buffer_load_dwordx4 v10, s[28:31], s40 offen offset:2048 nt lds
    buffer_load_dwordx4 v11, s[28:31], s40 offen offset:3072 nt lds
    s_mov_b32 m0, s43
    s_add_u32 s40, s40, 4096
    buffer_load_dwordx4 v10, s[28:31], s40 offen nt lds
    buffer_load_dwordx4 v11, s[28:31], s40 offen offset:1024 nt lds
    buffer_load_dwordx4 v10, s[28:31], s40 offen offset:2048 nt lds
    buffer_load_dwordx4 v11, s[28:31], s40 offen offset:3072 nt lds
    s_add_u32 s40, s40, 4096
    s_add_u32 s41, s41, 8192
    s_cmp_eq_u32 s41, s27
    s_cselect_b32 s41, s26, s41
    s_sub_u32 s53, s53, 1
    s_cmp_lg_u32 s53, 0
    s_cbranch_scc1 L_vq5
    s_mov_b32 s42, -3
    s_mov_b32 s54, 3
L_vd:
    s_sub_u32 s55, s54, s42
    s_cmp_eq_u32 s55, 2
    s_cbranch_scc1 L_vd1
    s_cmp_eq_u32 s55, 3
    s_cbranch_scc1 L_vd2
    s_cmp_eq_u32 s55, 4
    s_cbranch_scc1 L_vd3
    s_cmp_eq_u32 s55, 5
    s_cbranch_scc1 L_vd4
    s_cmp_ge_u32 s55, 6
    s_cbranch_scc1 L_vd5
    s_waitcnt vmcnt(0)
L_vd1:
    s_waitcnt vmcnt(8)
L_vd2:
    s_waitcnt vmcnt(16)
L_vd3:
    s_waitcnt vmcnt(24)
L_vd4:
    s_waitcnt vmcnt(32)
L_vd5:
    s_waitcnt vmcnt(40)
    s_barrier
    s_getreg_b32 s55, hwreg(HW_REG_IB_STS, 22, 2)
    s_getreg_b32 s56, hwreg(HW_REG_IB_STS, 0, 4)
    s_lshl_b32 s55, s55, 4
    s_or_b32 s56, s56, s55
L_vdi:
    s_cmp_le_u32 s54, 21
    s_cselect_b32 s57, 5, 3
    s_add_u32 s57, s57, s42
    s_cmp_lt_i32 s42, 0
    s_cselect_b32 s57, 4, s57
    s_min_u32 s57, s57, 31
    s_cmp_gt_u32 s54, s57
    s_cbranch_scc1 L_vdn
    s_cmp_le_u32 s56, 8
    s_cbranch_scc1 L_vdg
    s_add_u32 s57, s42, 1
    s_cmp_gt_i32 s54, s57
    s_cbranch_scc1 L_vdn
L_vdg:
    s_cmp_eq_u32 s54, 18
    s_cselect_b32 s26, 65536, s26
    s_mov_b32 m0, s41
    s_add_u32 s43, s41, 4096
    buffer_load_dwordx4 v10, s[28:31], s40 offen nt lds
    buffer_load_dwordx4 v11, s[28:31], s40 offen offset:1024 nt lds
    buffer_load_dwordx4 v10, s[28:31], s40 offen offset:2048 nt lds
    buffer_load_dwordx4 v11, s[28:31], s40 offen offset:3072 nt lds
    s_mov_b32 m0, s43
    s_add_u32 s40, s40, 4096
    buffer_load_dwordx4 v10, s[28:31], s40 offen nt lds
    buffer_load_dwordx4 v11, s[28:31], s40 offen offset:1024 nt lds
    buffer_load_dwordx4 v10, s[28:31], s40 offen offset:2048 nt lds
    buffer_load_dwordx4 v11, s[28:31], s40 offen offset:3072 nt lds
    s_add_u32 s40, s40, 4096
    s_add_u32 s41, s41, 8192
    s_cmp_eq_u32 s41, s27
    s_cselect_b32 s41, s26, s41
L_vdj:
    s_add_u32 s54, s54, 1
    s_add_u32 s56, s56, 8
    s_branch L_vdi
L_vdn:
    s_add_u32 s42, s42, 1
    s_cmp_lt_i32 s42, 32
    s_cbranch_scc1 L_vd
    s_barrier
    s_endpgm
    .p2align 8
L_compute:
    s_cmp_lg_u32 s20, 1
    s_cbranch_scc1 L_nopf
    s_getpc_b64 s[56:57]
L_pc:
    s_sub_u32 s56, s56, L_pc-L_start
    s_subb_u32 s57, s57, 0
    s_lshr_b32 s43, s2, 3
    s_and_b32 s43, s43, 7
    s_mul_i32 s43, s43, ((L_codeend-L_start+1023)/1024)*128
    v_lshlrev_b32 v1, 7, v0
    v_add_u32 v1, s43, v1
    v_min_u32 v1, L_codeend-L_start-4, v1
    v_mov_b32 v3, s57
    v_add_co_u32 v2, vcc, s56, v1
    s_nop 1
    v_addc_co_u32 v3, vcc, 0, v3, vcc
    v_cmp_gt_u32 vcc, (L_codeend-L_start+1023)/1024, v0
    s_nop 0
    s_and_saveexec_b64 s[58:59], vcc
    global_load_dword v251, v[2:3], off
    s_mov_b64 exec, -1
L_nopf:
    v_mov_b32 v252, 0
    v_mov_b32 v253, 0
    v_mov_b32 v254, 0
    v_mov_b32 v255, 0
    v_lshrrev_b32 v1, 4, v0
    v_and_b32 v2, 15, v0
    v_lshrrev_b32 v3, 5, v0
    v_and_b32 v4, 1, v1
    v_lshl_add_u32 v3, v4, 1, v3
    v_xor_b32 v3, v3, v2
    v_lshlrev_b32 v3, 4, v3
    v_lshl_add_u32 v8, v2, 8, v3
    v_xor_b32 v9, 64, v8
    v_xor_b32 v10, 128, v8
    v_xor_b32 v11, 192, v8
    s_lshl_b32 s43, s20, 12
    s_add_u32 s43, s43, 98304
    v_lshrrev_b32 v3, 1, v2
    v_xor_b32 v3, v3, v1
    v_lshlrev_b32 v3, 4, v3
    v_lshl_add_u32 v3, v2, 7, v3
    v_add_u32 v104, s43, v3
    v_xor_b32 v105, 64, v104
    v_bfe_u32 v2, v0, 2, 2
    v_lshrrev_b32 v3, 2, v0
    v_and_b32 v4, 7, v3
    v_lshlrev_b32 v4, 5, v4
    v_lshl_add_u32 v3, v3, 8, v4
    v_and_b32 v4, 3, v0
    v_lshl_add_u32 v3, v4, 3, v3
    v_add_u32 v16, 65536, v3
    v_xor_b32 v17, 32, v16
    v_xor_b32 v18, 64, v16
    v_xor_b32 v19, 96, v16
    v_xor_b32 v20, 128, v16
    v_xor_b32 v21, 160, v16
    v_xor_b32 v22, 192, v16
    v_xor_b32 v23, 224, v16
    v_lshl_add_u32 v3, v1, 10, v3
    v_add_u32 v96, 114688, v3
    v_xor_b32 v97, 32, v96
    v_xor_b32 v98, 64, v96
    v_xor_b32 v99, 96, v96
    v_xor_b32 v100, 128, v96
    v_xor_b32 v101, 160, v96
    v_xor_b32 v102, 192, v96
    v_xor_b32 v103, 224, v96
    v_mul_u32_u24 v2, 320, v2
    v_lshrrev_b32 v3, 5, v0
    v_lshl_add_u32 v3, v3, 11, v2
    v_and_b32 v4, 1, v1
    v_lshl_add_u32 v3, v4, 5, v3
    v_and_b32 v4, 1, v0
    v_lshl_add_u32 v3, v4, 4, v3
    v_bfe_u32 v4, v0, 1, 1
    v_lshl_add_u32 v3, v4, 3, v3
    s_lshl_b32 s43, s21, 5
    v_xor_b32 v12, s43, v3
    v_xor_b32 v13, 64, v12
    v_xor_b32 v14, 128, v12
    v_xor_b32 v15, 192, v12
    v_and_b32 v2, 31, v0
    s_lshl_b32 s43, s20, 5
    v_add_u32 v2, s43, v2
    v_lshlrev_b32 v4, 4, v0
    v_cmp_lt_u32 vcc, 111, v2
    v_bfrev_b32 v3, 1
    v_lshlrev_b32 v2, 10, v2
    v_cndmask_b32 v1, 0, v3, vcc
    v_or_b32 v4, v4, v1
    v_lshrrev_b32 v1, 5, v0
    v_lshl_add_u32 v7, v1, 4, v2
    v_xor_b32 v1, s25, v0
    v_lshlrev_b32 v1, 11, v1
    v_cmp_gt_u32 vcc, 4, v0
    v_add_u32 v2, 512, v1
    s_lshl_b32 s43, s20, 7
    v_cndmask_b32 v242, v3, v2, vcc
    v_lshl_add_u32 v2, v0, 2, s43
    v_add_u32 v1, v1, v2
    s_lshl_b32 s44, s25, 11
    v_add_u32 v2, s44, v2
    v_subrev_u32 v6, 1, v0
    v_cmp_gt_u32 vcc, 3, v6
    s_mov_b32 s46, 0x3e0293ee
    s_mov_b32 s47, 0x3e0293ee
    v_cndmask_b32 v240, v3, v1, vcc
    v_cndmask_b32 v3, v3, v2, vcc
    v_mfma_f32_32x32x16_bf16 v[32:47], v[252:255], v[252:255], 0
    v_mfma_f32_32x32x16_bf16 v[48:63], v[252:255], v[252:255], 0
    v_mfma_f32_32x32x16_bf16 v[64:79], v[252:255], v[252:255], 0
    v_mfma_f32_32x32x16_bf16 v[80:95], v[252:255], v[252:255], 0
    s_mov_b32 s52, 0x41000000
    s_waitcnt lgkmcnt(0)
    s_mov_b32 s28, s18
    s_mov_b32 s29, s19
    s_mov_b32 s30, 0x10000000
    s_mov_b32 s31, 0x20000
    s_lshl_b32 s49, s25, 15
    s_lshl_b32 s43, s20, 13
    s_add_u32 s49, s49, s43
    s_add_u32 s49, s49, 1048576
    s_mov_b32 s45, 1214788
    s_mov_b32 s42, 8
    s_cmp_eq_u32 s20, 3
    s_cbranch_scc1 L_paths
L_pathd:
    s_barrier
    ds_read_b128 v[224:227], v104 offset:0
    ds_read_b128 v[228:231], v104 offset:2048
    ds_read_b64_tr_b16 v[192:193], v96 offset:0
    ds_read_b64_tr_b16 v[194:195], v96 offset:1024
    ds_read_b64_tr_b16 v[196:197], v97 offset:0
    ds_read_b64_tr_b16 v[198:199], v97 offset:1024
    ds_read_b64_tr_b16 v[200:201], v98 offset:0
    ds_read_b64_tr_b16 v[202:203], v98 offset:1024
    ds_read_b64_tr_b16 v[204:205], v99 offset:0
    ds_read_b64_tr_b16 v[206:207], v99 offset:1024
    ds_read_b64_tr_b16 v[208:209], v100 offset:0
    ds_read_b64_tr_b16 v[210:211], v100 offset:1024
    ds_read_b64_tr_b16 v[212:213], v101 offset:0
    ds_read_b64_tr_b16 v[214:215], v101 offset:1024
    ds_read_b64_tr_b16 v[216:217], v102 offset:0
    ds_read_b64_tr_b16 v[218:219], v102 offset:1024
    ds_read_b64_tr_b16 v[220:221], v103 offset:0
    ds_read_b64_tr_b16 v[222:223], v103 offset:1024
L_qd:
    s_waitcnt lgkmcnt(14)
    v_mfma_f32_16x16x32_bf16 v[32:35], v[192:195], v[224:227], v[32:35]
    ds_read_b128 v[232:235], v105 offset:0
    ds_read_b128 v[236:239], v105 offset:2048
    v_mfma_f32_16x16x32_bf16 v[64:67], v[192:195], v[228:231], v[64:67]
    ds_read_b64_tr_b16 v[128:129], v96 offset:8192
    s_and_b32 s48, s45, 7
    s_lshr_b32 s45, s45, 3
    s_waitcnt lgkmcnt(15)
    v_mfma_f32_16x16x32_bf16 v[36:39], v[196:199], v[224:227], v[36:39]
    ds_read_b64_tr_b16 v[130:131], v96 offset:9216
    ds_read_b64_tr_b16 v[132:133], v97 offset:8192
    v_mfma_f32_16x16x32_bf16 v[68:71], v[196:199], v[228:231], v[68:71]
    ds_read_b64_tr_b16 v[134:135], v97 offset:9216
    s_sub_u32 s48, s48, 3
    s_lshl_b32 s48, s48, 15
    s_waitcnt lgkmcnt(15)
    v_mfma_f32_16x16x32_bf16 v[40:43], v[200:203], v[224:227], v[40:43]
    ds_read_b64_tr_b16 v[136:137], v98 offset:8192
    ds_read_b64_tr_b16 v[138:139], v98 offset:9216
    v_mfma_f32_16x16x32_bf16 v[72:75], v[200:203], v[228:231], v[72:75]
    ds_read_b64_tr_b16 v[140:141], v99 offset:8192
    s_waitcnt lgkmcnt(15)
    v_mfma_f32_16x16x32_bf16 v[44:47], v[204:207], v[224:227], v[44:47]
    ds_read_b64_tr_b16 v[142:143], v99 offset:9216
    v_mfma_f32_16x16x32_bf16 v[76:79], v[204:207], v[228:231], v[76:79]
    ds_read_b64_tr_b16 v[144:145], v100 offset:8192
    v_mfma_f32_16x16x32_bf16 v[48:51], v[208:211], v[224:227], v[48:51]
    ds_read_b64_tr_b16 v[146:147], v100 offset:9216
    v_mfma_f32_16x16x32_bf16 v[80:83], v[208:211], v[228:231], v[80:83]
    ds_read_b64_tr_b16 v[148:149], v101 offset:8192
    s_waitcnt lgkmcnt(15)
    v_mfma_f32_16x16x32_bf16 v[52:55], v[212:215], v[224:227], v[52:55]
    ds_read_b64_tr_b16 v[150:151], v101 offset:9216
    v_mfma_f32_16x16x32_bf16 v[84:87], v[212:215], v[228:231], v[84:87]
    ds_read_b64_tr_b16 v[152:153], v102 offset:8192
    v_mfma_f32_16x16x32_bf16 v[56:59], v[216:219], v[224:227], v[56:59]
    ds_read_b64_tr_b16 v[154:155], v102 offset:9216
    v_mfma_f32_16x16x32_bf16 v[88:91], v[216:219], v[228:231], v[88:91]
    ds_read_b64_tr_b16 v[156:157], v103 offset:8192
    s_waitcnt lgkmcnt(15)
    v_mfma_f32_16x16x32_bf16 v[60:63], v[220:223], v[224:227], v[60:63]
    ds_read_b64_tr_b16 v[158:159], v103 offset:9216
    v_mfma_f32_16x16x32_bf16 v[92:95], v[220:223], v[228:231], v[92:95]
    s_cmp_lg_u32 s42, 3
    s_cbranch_scc1 L_qnbd
    s_barrier
L_qnbd:
    s_waitcnt lgkmcnt(14)
    v_mfma_f32_16x16x32_bf16 v[32:35], v[128:131], v[232:235], v[32:35]
    v_add_u32 v96, s48, v96
    v_add_u32 v97, s48, v97
    v_mfma_f32_16x16x32_bf16 v[64:67], v[128:131], v[236:239], v[64:67]
    v_add_u32 v98, s48, v98
    v_add_u32 v99, s48, v99
    s_waitcnt lgkmcnt(12)
    v_mfma_f32_16x16x32_bf16 v[36:39], v[132:135], v[232:235], v[36:39]
    v_add_u32 v100, s48, v100
    v_add_u32 v101, s48, v101
    v_mfma_f32_16x16x32_bf16 v[68:71], v[132:135], v[236:239], v[68:71]
    v_add_u32 v102, s48, v102
    v_add_u32 v103, s48, v103
    s_waitcnt lgkmcnt(10)
    v_mfma_f32_16x16x32_bf16 v[40:43], v[136:139], v[232:235], v[40:43]
    v_add_u32 v104, s48, v104
    v_mfma_f32_16x16x32_bf16 v[72:75], v[136:139], v[236:239], v[72:75]
    v_add_u32 v105, s48, v105
    s_waitcnt lgkmcnt(0)
    s_barrier
    v_mfma_f32_16x16x32_bf16 v[44:47], v[140:143], v[232:235], v[44:47]
    ds_read_b128 v[224:227], v104 offset:0
    ds_read_b128 v[228:231], v104 offset:2048
    v_mfma_f32_16x16x32_bf16 v[76:79], v[140:143], v[236:239], v[76:79]
    ds_read_b64_tr_b16 v[192:193], v96 offset:0
    ds_read_b64_tr_b16 v[194:195], v96 offset:1024
    v_mfma_f32_16x16x32_bf16 v[48:51], v[144:147], v[232:235], v[48:51]
    ds_read_b64_tr_b16 v[196:197], v97 offset:0
    ds_read_b64_tr_b16 v[198:199], v97 offset:1024
    v_mfma_f32_16x16x32_bf16 v[80:83], v[144:147], v[236:239], v[80:83]
    ds_read_b64_tr_b16 v[200:201], v98 offset:0
    ds_read_b64_tr_b16 v[202:203], v98 offset:1024
    v_mfma_f32_16x16x32_bf16 v[52:55], v[148:151], v[232:235], v[52:55]
    ds_read_b64_tr_b16 v[204:205], v99 offset:0
    ds_read_b64_tr_b16 v[206:207], v99 offset:1024
    v_mfma_f32_16x16x32_bf16 v[84:87], v[148:151], v[236:239], v[84:87]
    ds_read_b64_tr_b16 v[208:209], v100 offset:0
    ds_read_b64_tr_b16 v[210:211], v100 offset:1024
    v_mfma_f32_16x16x32_bf16 v[56:59], v[152:155], v[232:235], v[56:59]
    ds_read_b64_tr_b16 v[212:213], v101 offset:0
    ds_read_b64_tr_b16 v[214:215], v101 offset:1024
    v_mfma_f32_16x16x32_bf16 v[88:91], v[152:155], v[236:239], v[88:91]
    ds_read_b64_tr_b16 v[216:217], v102 offset:0
    ds_read_b64_tr_b16 v[218:219], v102 offset:1024
    v_mfma_f32_16x16x32_bf16 v[60:63], v[156:159], v[232:235], v[60:63]
    ds_read_b64_tr_b16 v[220:221], v103 offset:0
    v_mfma_f32_16x16x32_bf16 v[92:95], v[156:159], v[236:239], v[92:95]
    ds_read_b64_tr_b16 v[222:223], v103 offset:1024
    s_sub_u32 s42, s42, 1
    s_cmp_lg_u32 s42, 0
    s_cbranch_scc1 L_qd
    s_waitcnt lgkmcnt(0)
    ds_read_b128 v[160:163], v8 offset:0
    ds_read_b128 v[176:179], v8 offset:4096
    ds_read_b128 v[164:167], v9 offset:0
    ds_read_b128 v[180:183], v9 offset:4096
    ds_read_b128 v[168:171], v10 offset:0
    ds_read_b128 v[184:187], v10 offset:4096
    ds_read_b128 v[172:175], v11 offset:0
    ds_read_b128 v[188:191], v11 offset:4096
    s_waitcnt vmcnt(0)
    v_pk_mul_f32 v[32:33], v[32:33], s[46:47]
    v_pk_mul_f32 v[34:35], v[34:35], s[46:47]
    v_pk_mul_f32 v[36:37], v[36:37], s[46:47]
    v_pk_mul_f32 v[38:39], v[38:39], s[46:47]
    v_cvt_pk_bf16_f32 v96, v32, v33
    v_cvt_pk_bf16_f32 v97, v34, v35
    v_cvt_pk_bf16_f32 v98, v36, v37
    v_cvt_pk_bf16_f32 v99, v38, v39
    v_pk_mul_f32 v[64:65], v[64:65], s[46:47]
    v_pk_mul_f32 v[66:67], v[66:67], s[46:47]
    v_pk_mul_f32 v[68:69], v[68:69], s[46:47]
    v_pk_mul_f32 v[70:71], v[70:71], s[46:47]
    v_cvt_pk_bf16_f32 v112, v64, v65
    v_cvt_pk_bf16_f32 v113, v66, v67
    v_cvt_pk_bf16_f32 v114, v68, v69
    v_cvt_pk_bf16_f32 v115, v70, v71
    v_permlane16_swap_b32 v96, v98
    v_permlane16_swap_b32 v97, v99
    v_permlane16_swap_b32 v112, v114
    v_permlane16_swap_b32 v113, v115
    v_mov_b32 v232, 0
    v_mov_b32 v233, 0
    v_mov_b32 v234, 0
    v_mov_b32 v235, 0
    s_waitcnt lgkmcnt(7)
    v_mfma_f32_16x16x32_bf16 v[128:131], v[160:163], v[96:99], 0
    v_mul_f32 v40, s46, v40
    v_mul_f32 v41, s46, v41
    v_mul_f32 v42, s46, v42
    v_mul_f32 v43, s46, v43
    v_mul_f32 v44, s46, v44
    v_mul_f32 v45, s46, v45
    v_mul_f32 v46, s46, v46
    v_mfma_f32_16x16x32_bf16 v[136:139], v[160:163], v[112:115], 0
    v_mul_f32 v47, s46, v47
    v_cvt_pk_bf16_f32 v100, v40, v41
    v_cvt_pk_bf16_f32 v101, v42, v43
    v_cvt_pk_bf16_f32 v102, v44, v45
    v_cvt_pk_bf16_f32 v103, v46, v47
    v_mul_f32 v72, s46, v72
    v_mul_f32 v73, s46, v73
    s_waitcnt lgkmcnt(6)
    v_mfma_f32_16x16x32_bf16 v[132:135], v[176:179], v[96:99], 0
    ds_read_b128 v[160:163], v8 offset:8192
    v_mul_f32 v74, s46, v74
    v_mul_f32 v75, s46, v75
    v_mul_f32 v76, s46, v76
    v_mul_f32 v77, s46, v77
    v_mul_f32 v78, s46, v78
    v_mul_f32 v79, s46, v79
    v_cvt_pk_bf16_f32 v116, v72, v73
    v_mfma_f32_16x16x32_bf16 v[140:143], v[176:179], v[112:115], 0
    v_cvt_pk_bf16_f32 v117, v74, v75
    v_cvt_pk_bf16_f32 v118, v76, v77
    v_cvt_pk_bf16_f32 v119, v78, v79
    v_permlane16_swap_b32 v100, v102
    v_permlane16_swap_b32 v101, v103
    v_permlane16_swap_b32 v116, v118
    v_permlane16_swap_b32 v117, v119
    s_waitcnt lgkmcnt(6)
    v_mfma_f32_16x16x32_bf16 v[128:131], v[164:167], v[100:103], v[128:131]
    ds_read_b128 v[176:179], v8 offset:12288
    v_mul_f32 v48, s46, v48
    v_mul_f32 v49, s46, v49
    v_mul_f32 v50, s46, v50
    v_mul_f32 v51, s46, v51
    v_mul_f32 v52, s46, v52
    v_mul_f32 v53, s46, v53
    v_mul_f32 v54, s46, v54
    v_mfma_f32_16x16x32_bf16 v[136:139], v[164:167], v[116:119], v[136:139]
    v_mul_f32 v55, s46, v55
    v_cvt_pk_bf16_f32 v104, v48, v49
    v_cvt_pk_bf16_f32 v105, v50, v51
    v_cvt_pk_bf16_f32 v106, v52, v53
    v_cvt_pk_bf16_f32 v107, v54, v55
    v_mul_f32 v80, s46, v80
    v_mul_f32 v81, s46, v81
    s_waitcnt lgkmcnt(6)
    v_mfma_f32_16x16x32_bf16 v[132:135], v[180:183], v[100:103], v[132:135]
    ds_read_b128 v[164:167], v9 offset:8192
    v_mul_f32 v82, s46, v82
    v_mul_f32 v83, s46, v83
    v_mul_f32 v84, s46, v84
    v_mul_f32 v85, s46, v85
    v_mul_f32 v86, s46, v86
    v_mul_f32 v87, s46, v87
    v_cvt_pk_bf16_f32 v120, v80, v81
    v_mfma_f32_16x16x32_bf16 v[140:143], v[180:183], v[116:119], v[140:143]
    v_cvt_pk_bf16_f32 v121, v82, v83
    v_cvt_pk_bf16_f32 v122, v84, v85
    v_cvt_pk_bf16_f32 v123, v86, v87
    v_permlane16_swap_b32 v104, v106
    v_permlane16_swap_b32 v105, v107
    v_permlane16_swap_b32 v120, v122
    v_permlane16_swap_b32 v121, v123
    s_waitcnt lgkmcnt(6)
    v_mfma_f32_16x16x32_bf16 v[128:131], v[168:171], v[104:107], v[128:131]
    ds_read_b128 v[180:183], v9 offset:12288
    v_mul_f32 v56, s46, v56
    v_mul_f32 v57, s46, v57
    v_mul_f32 v58, s46, v58
    v_mul_f32 v59, s46, v59
    v_mul_f32 v60, s46, v60
    v_mul_f32 v61, s46, v61
    v_mul_f32 v62, s46, v62
    v_mfma_f32_16x16x32_bf16 v[136:139], v[168:171], v[120:123], v[136:139]
    v_mul_f32 v63, s46, v63
    v_cvt_pk_bf16_f32 v108, v56, v57
    v_cvt_pk_bf16_f32 v109, v58, v59
    v_cvt_pk_bf16_f32 v110, v60, v61
    v_cvt_pk_bf16_f32 v111, v62, v63
    v_mul_f32 v88, s46, v88
    v_mul_f32 v89, s46, v89
    s_waitcnt lgkmcnt(6)
    v_mfma_f32_16x16x32_bf16 v[132:135], v[184:187], v[104:107], v[132:135]
    ds_read_b128 v[168:171], v10 offset:8192
    v_mul_f32 v90, s46, v90
    v_mul_f32 v91, s46, v91
    v_mul_f32 v92, s46, v92
    v_mul_f32 v93, s46, v93
    v_mul_f32 v94, s46, v94
    v_mul_f32 v95, s46, v95
    v_cvt_pk_bf16_f32 v124, v88, v89
    v_mfma_f32_16x16x32_bf16 v[140:143], v[184:187], v[120:123], v[140:143]
    v_cvt_pk_bf16_f32 v125, v90, v91
    v_cvt_pk_bf16_f32 v126, v92, v93
    v_cvt_pk_bf16_f32 v127, v94, v95
    v_permlane16_swap_b32 v108, v110
    v_permlane16_swap_b32 v109, v111
    v_permlane16_swap_b32 v124, v126
    v_permlane16_swap_b32 v125, v127
    s_waitcnt lgkmcnt(6)
    v_mfma_f32_16x16x32_bf16 v[128:131], v[172:175], v[108:111], v[128:131]
    ds_read_b128 v[184:187], v10 offset:12288
    v_mov_b32 v236, 0
    v_mov_b32 v237, 0
    v_mfma_f32_16x16x32_bf16 v[136:139], v[172:175], v[124:127], v[136:139]
    v_mov_b32 v238, 0
    v_mov_b32 v239, 0
    s_waitcnt lgkmcnt(6)
    v_mfma_f32_16x16x32_bf16 v[132:135], v[188:191], v[108:111], v[132:135]
    ds_read_b128 v[172:175], v11 offset:8192
    v_mov_b32 v244, 0x3f803f80
    v_mov_b32 v245, 0x3f803f80
    v_mfma_f32_16x16x32_bf16 v[140:143], v[188:191], v[124:127], v[140:143]
    v_mov_b32 v246, 0x3f803f80
    v_mov_b32 v247, 0x3f803f80
    v_mfma_f32_32x32x16_bf16 v[32:47], v[232:235], v[232:235], 0
    ds_read_b128 v[188:191], v11 offset:12288
    v_mfma_f32_32x32x16_bf16 v[48:63], v[232:235], v[232:235], 0
    v_mfma_f32_32x32x16_bf16 v[64:79], v[232:235], v[232:235], 0
    v_mfma_f32_32x32x16_bf16 v[80:95], v[232:235], v[232:235], 0
    v_add_u32 v8, 16384, v8
    v_add_u32 v9, 16384, v9
    v_add_u32 v10, 16384, v10
    v_add_u32 v11, 16384, v11
    v_max3_f32 v1, v128, v129, v130
    v_max3_f32 v6, v136, v137, v138
    v_max3_f32 v1, v1, v131, v132
    v_max3_f32 v6, v6, v139, v140
    v_max3_f32 v1, v1, v133, v134
    v_max3_f32 v6, v6, v141, v142
    v_max_f32 v1, v1, v135
    v_max_f32 v6, v6, v143
    v_mov_b32 v2, v1
    v_mov_b32 v29, v6
    s_nop 0
    v_permlane32_swap_b32 v2, v1
    v_permlane32_swap_b32 v29, v6
    v_max_f32 v1, v2, v1
    v_max_f32 v6, v29, v6
    v_mov_b32 v2, v1
    v_mov_b32 v29, v6
    s_nop 0
    v_permlane16_swap_b32 v2, v1
    v_permlane16_swap_b32 v29, v6
    v_max_f32 v1, v2, v1
    v_max_f32 v6, v29, v6
    v_sub_f32 v24, 0, v1
    v_sub_f32 v28, 0, v6
    v_mov_b32 v25, v24
    v_mov_b32 v29, v28
    v_mov_b32 v26, v24
    v_mov_b32 v30, v28
    v_mov_b32 v27, v24
    v_mov_b32 v31, v28
    v_add_f32 v128, v128, v24
    v_add_f32 v136, v136, v28
    v_add_f32 v129, v129, v24
    v_add_f32 v137, v137, v28
    v_add_f32 v130, v130, v24
    v_add_f32 v138, v138, v28
    v_add_f32 v131, v131, v24
    v_add_f32 v139, v139, v28
    v_add_f32 v132, v132, v24
    v_add_f32 v140, v140, v28
    v_add_f32 v133, v133, v24
    v_add_f32 v141, v141, v28
    v_add_f32 v134, v134, v24
    v_add_f32 v142, v142, v28
    v_add_f32 v135, v135, v24
    v_add_f32 v143, v143, v28
    s_mov_b32 s54, 0x27773cf3
    s_mov_b32 s55, 0x1ddf3cf3
    s_mov_b32 s42, 15
    .p2align 6
L_attd:
    s_waitcnt lgkmcnt(0)
    s_barrier
    v_mfma_f32_16x16x32_bf16 v[144:147], v[160:163], v[96:99], v[24:27]
    v_exp_f32 v128, v128
    v_mfma_f32_16x16x32_bf16 v[152:155], v[160:163], v[112:115], v[28:31]
    ds_read_b64_tr_b16 v[192:193], v16 offset:0
    ds_read_b64_tr_b16 v[194:195], v16 offset:4096
    v_mfma_f32_16x16x32_bf16 v[148:151], v[176:179], v[96:99], v[24:27]
    v_exp_f32 v129, v129
    v_mfma_f32_16x16x32_bf16 v[156:159], v[176:179], v[112:115], v[28:31]
    ds_read_b64_tr_b16 v[196:197], v17 offset:0
    v_cvt_pk_bf16_f32 v224, v128, v129
    v_mfma_f32_16x16x32_bf16 v[144:147], v[164:167], v[100:103], v[144:147]
    v_exp_f32 v130, v130
    v_mfma_f32_16x16x32_bf16 v[152:155], v[164:167], v[116:119], v[152:155]
    ds_read_b64_tr_b16 v[198:199], v17 offset:4096
    ds_read_b64_tr_b16 v[200:201], v18 offset:0
    v_mfma_f32_16x16x32_bf16 v[148:151], v[180:183], v[100:103], v[148:151]
    v_exp_f32 v131, v131
    v_mfma_f32_16x16x32_bf16 v[156:159], v[180:183], v[116:119], v[156:159]
    ds_read_b64_tr_b16 v[202:203], v18 offset:4096
    v_cvt_pk_bf16_f32 v225, v130, v131
    v_mfma_f32_16x16x32_bf16 v[144:147], v[168:171], v[104:107], v[144:147]
    v_exp_f32 v132, v132
    v_mfma_f32_16x16x32_bf16 v[152:155], v[168:171], v[120:123], v[152:155]
    ds_read_b64_tr_b16 v[204:205], v19 offset:0
    ds_read_b64_tr_b16 v[206:207], v19 offset:4096
    v_mfma_f32_16x16x32_bf16 v[148:151], v[184:187], v[104:107], v[148:151]
    v_exp_f32 v133, v133
    v_mfma_f32_16x16x32_bf16 v[156:159], v[184:187], v[120:123], v[156:159]
    ds_read_b64_tr_b16 v[208:209], v20 offset:0
    v_cvt_pk_bf16_f32 v226, v132, v133
    v_mfma_f32_16x16x32_bf16 v[144:147], v[172:175], v[108:111], v[144:147]
    v_exp_f32 v134, v134
    v_mfma_f32_16x16x32_bf16 v[152:155], v[172:175], v[124:127], v[152:155]
    ds_read_b64_tr_b16 v[210:211], v20 offset:4096
    v_exp_f32 v135, v135
    v_mfma_f32_16x16x32_bf16 v[148:151], v[188:191], v[108:111], v[148:151]
    ds_read_b64_tr_b16 v[212:213], v21 offset:0
    v_cvt_pk_bf16_f32 v227, v134, v135
    v_mfma_f32_16x16x32_bf16 v[156:159], v[188:191], v[124:127], v[156:159]
    ds_read_b64_tr_b16 v[214:215], v21 offset:4096
    v_exp_f32 v136, v136
    s_waitcnt lgkmcnt(4)
    v_mfma_f32_16x16x32_bf16 v[32:35], v[192:195], v[224:227], v[32:35]
    ds_read_b64_tr_b16 v[216:217], v22 offset:0
    ds_read_b64_tr_b16 v[218:219], v22 offset:4096
    v_mfma_f32_16x16x32_bf16 v[36:39], v[196:199], v[224:227], v[36:39]
    ds_read_b64_tr_b16 v[220:221], v23 offset:0
    v_exp_f32 v137, v137
    v_mfma_f32_16x16x32_bf16 v[40:43], v[200:203], v[224:227], v[40:43]
    ds_read_b64_tr_b16 v[222:223], v23 offset:4096
    v_exp_f32 v138, v138
    v_mfma_f32_16x16x32_bf16 v[44:47], v[204:207], v[224:227], v[44:47]
    v_cvt_pk_bf16_f32 v228, v136, v137
    v_exp_f32 v139, v139
    s_waitcnt lgkmcnt(4)
    v_mfma_f32_16x16x32_bf16 v[48:51], v[208:211], v[224:227], v[48:51]
    v_exp_f32 v140, v140
    v_mfma_f32_16x16x32_bf16 v[52:55], v[212:215], v[224:227], v[52:55]
    v_cvt_pk_bf16_f32 v229, v138, v139
    v_exp_f32 v141, v141
    s_waitcnt lgkmcnt(2)
    v_mfma_f32_16x16x32_bf16 v[56:59], v[216:219], v[224:227], v[56:59]
    v_exp_f32 v142, v142
    s_waitcnt lgkmcnt(0)
    v_mfma_f32_16x16x32_bf16 v[60:63], v[220:223], v[224:227], v[60:63]
    v_cvt_pk_bf16_f32 v230, v140, v141
    v_exp_f32 v143, v143
    v_mfma_f32_16x16x32_bf16 v[232:235], v[244:247], v[224:227], v[232:235]
    ds_read_b128 v[160:163], v8 offset:0
    v_cvt_pk_bf16_f32 v231, v142, v143
    v_max3_f32 v6, v144, v145, v146
    v_max3_f32 v6, v6, v147, v148
    v_mfma_f32_16x16x32_bf16 v[64:67], v[192:195], v[228:231], v[64:67]
    ds_read_b128 v[176:179], v8 offset:4096
    ds_read_b128 v[164:167], v9 offset:0
    v_mfma_f32_16x16x32_bf16 v[68:71], v[196:199], v[228:231], v[68:71]
    ds_read_b128 v[180:183], v9 offset:4096
    v_max3_f32 v6, v6, v149, v150
    v_mfma_f32_16x16x32_bf16 v[72:75], v[200:203], v[228:231], v[72:75]
    ds_read_b128 v[168:171], v10 offset:0
    v_max3_f32 v6, v6, v151, v152
    v_mfma_f32_16x16x32_bf16 v[76:79], v[204:207], v[228:231], v[76:79]
    ds_read_b128 v[184:187], v10 offset:4096
    v_max3_f32 v6, v6, v153, v154
    v_mfma_f32_16x16x32_bf16 v[80:83], v[208:211], v[228:231], v[80:83]
    ds_read_b128 v[172:175], v11 offset:0
    v_max3_f32 v6, v6, v155, v156
    v_mfma_f32_16x16x32_bf16 v[84:87], v[212:215], v[228:231], v[84:87]
    ds_read_b128 v[188:191], v11 offset:4096
    v_max3_f32 v6, v6, v157, v158
    v_mfma_f32_16x16x32_bf16 v[88:91], v[216:219], v[228:231], v[88:91]
    v_max_f32 v6, v6, v159
    v_mfma_f32_16x16x32_bf16 v[92:95], v[220:223], v[228:231], v[92:95]
    v_cmp_lt_f32 vcc, s52, v6
    v_mfma_f32_16x16x32_bf16 v[236:239], v[244:247], v[228:231], v[236:239]
    s_cbranch_vccnz L_rescad
L_backad:
    s_waitcnt lgkmcnt(0)
    s_barrier
    s_cmp_lg_u32 s42, 1
    s_cbranch_scc1 L_noinfod
    buffer_load_dword v243, v242, s[28:31], 0 offen sc1
L_noinfod:
    v_mfma_f32_16x16x32_bf16 v[128:131], v[160:163], v[96:99], v[24:27]
    v_exp_f32 v144, v144
    v_mfma_f32_16x16x32_bf16 v[136:139], v[160:163], v[112:115], v[28:31]
    ds_read_b64_tr_b16 v[192:193], v16 offset:8192
    ds_read_b64_tr_b16 v[194:195], v16 offset:12288
    s_and_b32 s56, s55, 3
    s_lshr_b32 s55, s55, 2
    v_mfma_f32_16x16x32_bf16 v[132:135], v[176:179], v[96:99], v[24:27]
    v_exp_f32 v145, v145
    v_mfma_f32_16x16x32_bf16 v[140:143], v[176:179], v[112:115], v[28:31]
    ds_read_b64_tr_b16 v[196:197], v17 offset:8192
    v_cvt_pk_bf16_f32 v224, v144, v145
    s_sub_u32 s56, s56, 2
    s_lshl_b32 s56, s56, 14
    v_mfma_f32_16x16x32_bf16 v[128:131], v[164:167], v[100:103], v[128:131]
    v_exp_f32 v146, v146
    v_mfma_f32_16x16x32_bf16 v[136:139], v[164:167], v[116:119], v[136:139]
    ds_read_b64_tr_b16 v[198:199], v17 offset:12288
    ds_read_b64_tr_b16 v[200:201], v18 offset:8192
    s_and_b32 s48, s54, 3
    s_lshr_b32 s54, s54, 2
    v_mfma_f32_16x16x32_bf16 v[132:135], v[180:183], v[100:103], v[132:135]
    v_exp_f32 v147, v147
    v_mfma_f32_16x16x32_bf16 v[140:143], v[180:183], v[116:119], v[140:143]
    ds_read_b64_tr_b16 v[202:203], v18 offset:12288
    v_cvt_pk_bf16_f32 v225, v146, v147
    s_sub_u32 s48, s48, 2
    s_lshl_b32 s48, s48, 14
    v_mfma_f32_16x16x32_bf16 v[128:131], v[168:171], v[104:107], v[128:131]
    v_exp_f32 v148, v148
    v_mfma_f32_16x16x32_bf16 v[136:139], v[168:171], v[120:123], v[136:139]
    ds_read_b64_tr_b16 v[204:205], v19 offset:8192
    ds_read_b64_tr_b16 v[206:207], v19 offset:12288
    v_mfma_f32_16x16x32_bf16 v[132:135], v[184:187], v[104:107], v[132:135]
    v_exp_f32 v149, v149
    v_mfma_f32_16x16x32_bf16 v[140:143], v[184:187], v[120:123], v[140:143]
    ds_read_b64_tr_b16 v[208:209], v20 offset:8192
    v_cvt_pk_bf16_f32 v226, v148, v149
    v_mfma_f32_16x16x32_bf16 v[128:131], v[172:175], v[108:111], v[128:131]
    v_exp_f32 v150, v150
    v_mfma_f32_16x16x32_bf16 v[136:139], v[172:175], v[124:127], v[136:139]
    ds_read_b64_tr_b16 v[210:211], v20 offset:12288
    v_exp_f32 v151, v151
    v_mfma_f32_16x16x32_bf16 v[132:135], v[188:191], v[108:111], v[132:135]
    ds_read_b64_tr_b16 v[212:213], v21 offset:8192
    v_cvt_pk_bf16_f32 v227, v150, v151
    v_mfma_f32_16x16x32_bf16 v[140:143], v[188:191], v[124:127], v[140:143]
    ds_read_b64_tr_b16 v[214:215], v21 offset:12288
    v_exp_f32 v152, v152
    s_waitcnt lgkmcnt(4)
    v_mfma_f32_16x16x32_bf16 v[32:35], v[192:195], v[224:227], v[32:35]
    ds_read_b64_tr_b16 v[216:217], v22 offset:8192
    ds_read_b64_tr_b16 v[218:219], v22 offset:12288
    v_mfma_f32_16x16x32_bf16 v[36:39], v[196:199], v[224:227], v[36:39]
    ds_read_b64_tr_b16 v[220:221], v23 offset:8192
    v_exp_f32 v153, v153
    v_mfma_f32_16x16x32_bf16 v[40:43], v[200:203], v[224:227], v[40:43]
    ds_read_b64_tr_b16 v[222:223], v23 offset:12288
    v_exp_f32 v154, v154
    v_mfma_f32_16x16x32_bf16 v[44:47], v[204:207], v[224:227], v[44:47]
    v_cvt_pk_bf16_f32 v228, v152, v153
    v_exp_f32 v155, v155
    s_waitcnt lgkmcnt(4)
    v_mfma_f32_16x16x32_bf16 v[48:51], v[208:211], v[224:227], v[48:51]
    v_exp_f32 v156, v156
    v_mfma_f32_16x16x32_bf16 v[52:55], v[212:215], v[224:227], v[52:55]
    v_cvt_pk_bf16_f32 v229, v154, v155
    v_exp_f32 v157, v157
    s_waitcnt lgkmcnt(2)
    v_mfma_f32_16x16x32_bf16 v[56:59], v[216:219], v[224:227], v[56:59]
    v_exp_f32 v158, v158
    s_waitcnt lgkmcnt(0)
    v_mfma_f32_16x16x32_bf16 v[60:63], v[220:223], v[224:227], v[60:63]
    v_cvt_pk_bf16_f32 v230, v156, v157
    v_exp_f32 v159, v159
    v_mfma_f32_16x16x32_bf16 v[232:235], v[244:247], v[224:227], v[232:235]
    ds_read_b128 v[160:163], v8 offset:8192
    v_cvt_pk_bf16_f32 v231, v158, v159
    v_max3_f32 v6, v128, v129, v130
    v_max3_f32 v6, v6, v131, v132
    v_mfma_f32_16x16x32_bf16 v[64:67], v[192:195], v[228:231], v[64:67]
    ds_read_b128 v[176:179], v8 offset:12288
    ds_read_b128 v[164:167], v9 offset:8192
    v_mfma_f32_16x16x32_bf16 v[68:71], v[196:199], v[228:231], v[68:71]
    ds_read_b128 v[180:183], v9 offset:12288
    v_max3_f32 v6, v6, v133, v134
    v_mfma_f32_16x16x32_bf16 v[72:75], v[200:203], v[228:231], v[72:75]
    ds_read_b128 v[168:171], v10 offset:8192
    v_max3_f32 v6, v6, v135, v136
    v_mfma_f32_16x16x32_bf16 v[76:79], v[204:207], v[228:231], v[76:79]
    ds_read_b128 v[184:187], v10 offset:12288
    v_max3_f32 v6, v6, v137, v138
    v_mfma_f32_16x16x32_bf16 v[80:83], v[208:211], v[228:231], v[80:83]
    ds_read_b128 v[172:175], v11 offset:8192
    v_max3_f32 v6, v6, v139, v140
    v_mfma_f32_16x16x32_bf16 v[84:87], v[212:215], v[228:231], v[84:87]
    ds_read_b128 v[188:191], v11 offset:12288
    v_max3_f32 v6, v6, v141, v142
    v_mfma_f32_16x16x32_bf16 v[88:91], v[216:219], v[228:231], v[88:91]
    v_max_f32 v6, v6, v143
    v_add_u32 v16, s56, v16
    v_mfma_f32_16x16x32_bf16 v[92:95], v[220:223], v[228:231], v[92:95]
    v_cmp_lt_f32 vcc, s52, v6
    v_add_u32 v17, s56, v17
    v_mfma_f32_16x16x32_bf16 v[236:239], v[244:247], v[228:231], v[236:239]
    v_add_u32 v18, s56, v18
    v_add_u32 v19, s56, v19
    v_add_u32 v20, s56, v20
    v_add_u32 v21, s56, v21
    v_add_u32 v22, s56, v22
    v_add_u32 v23, s56, v23
    v_add_u32 v8, s48, v8
    v_add_u32 v9, s48, v9
    v_add_u32 v10, s48, v10
    v_add_u32 v11, s48, v11
    s_cbranch_vccnz L_rescbd
L_backbd:
    s_sub_u32 s42, s42, 1
    s_cmp_lg_u32 s42, 0
    s_cbranch_scc1 L_attd
    s_waitcnt lgkmcnt(0)
    s_barrier
    v_add_u32 v8, 98304, v12
    v_add_u32 v9, 98304, v13
    v_add_u32 v10, 98304, v14
    v_add_u32 v11, 98304, v15
    v_mfma_f32_16x16x32_bf16 v[144:147], v[160:163], v[96:99], v[24:27]
    v_exp_f32 v128, v128
    v_mfma_f32_16x16x32_bf16 v[152:155], v[160:163], v[112:115], v[28:31]
    ds_read_b64_tr_b16 v[192:193], v16 offset:0
    ds_read_b64_tr_b16 v[194:195], v16 offset:4096
    v_mfma_f32_16x16x32_bf16 v[148:151], v[176:179], v[96:99], v[24:27]
    v_exp_f32 v129, v129
    v_mfma_f32_16x16x32_bf16 v[156:159], v[176:179], v[112:115], v[28:31]
    ds_read_b64_tr_b16 v[196:197], v17 offset:0
    v_cvt_pk_bf16_f32 v224, v128, v129
    v_mfma_f32_16x16x32_bf16 v[144:147], v[164:167], v[100:103], v[144:147]
    v_exp_f32 v130, v130
    v_mfma_f32_16x16x32_bf16 v[152:155], v[164:167], v[116:119], v[152:155]
    ds_read_b64_tr_b16 v[198:199], v17 offset:4096
    ds_read_b64_tr_b16 v[200:201], v18 offset:0
    v_mfma_f32_16x16x32_bf16 v[148:151], v[180:183], v[100:103], v[148:151]
    v_exp_f32 v131, v131
    v_mfma_f32_16x16x32_bf16 v[156:159], v[180:183], v[116:119], v[156:159]
    ds_read_b64_tr_b16 v[202:203], v18 offset:4096
    v_cvt_pk_bf16_f32 v225, v130, v131
    v_mfma_f32_16x16x32_bf16 v[144:147], v[168:171], v[104:107], v[144:147]
    v_exp_f32 v132, v132
    v_mfma_f32_16x16x32_bf16 v[152:155], v[168:171], v[120:123], v[152:155]
    ds_read_b64_tr_b16 v[204:205], v19 offset:0
    ds_read_b64_tr_b16 v[206:207], v19 offset:4096
    v_mfma_f32_16x16x32_bf16 v[148:151], v[184:187], v[104:107], v[148:151]
    v_exp_f32 v133, v133
    v_mfma_f32_16x16x32_bf16 v[156:159], v[184:187], v[120:123], v[156:159]
    ds_read_b64_tr_b16 v[208:209], v20 offset:0
    v_cvt_pk_bf16_f32 v226, v132, v133
    v_mfma_f32_16x16x32_bf16 v[144:147], v[172:175], v[108:111], v[144:147]
    v_exp_f32 v134, v134
    v_mfma_f32_16x16x32_bf16 v[152:155], v[172:175], v[124:127], v[152:155]
    ds_read_b64_tr_b16 v[210:211], v20 offset:4096
    v_exp_f32 v135, v135
    v_mfma_f32_16x16x32_bf16 v[148:151], v[188:191], v[108:111], v[148:151]
    ds_read_b64_tr_b16 v[212:213], v21 offset:0
    v_cvt_pk_bf16_f32 v227, v134, v135
    v_mfma_f32_16x16x32_bf16 v[156:159], v[188:191], v[124:127], v[156:159]
    ds_read_b64_tr_b16 v[214:215], v21 offset:4096
    v_exp_f32 v136, v136
    s_waitcnt lgkmcnt(4)
    v_mfma_f32_16x16x32_bf16 v[32:35], v[192:195], v[224:227], v[32:35]
    ds_read_b64_tr_b16 v[216:217], v22 offset:0
    ds_read_b64_tr_b16 v[218:219], v22 offset:4096
    v_mfma_f32_16x16x32_bf16 v[36:39], v[196:199], v[224:227], v[36:39]
    ds_read_b64_tr_b16 v[220:221], v23 offset:0
    v_exp_f32 v137, v137
    v_mfma_f32_16x16x32_bf16 v[40:43], v[200:203], v[224:227], v[40:43]
    ds_read_b64_tr_b16 v[222:223], v23 offset:4096
    v_exp_f32 v138, v138
    v_mfma_f32_16x16x32_bf16 v[44:47], v[204:207], v[224:227], v[44:47]
    v_cvt_pk_bf16_f32 v228, v136, v137
    v_exp_f32 v139, v139
    s_waitcnt lgkmcnt(4)
    v_mfma_f32_16x16x32_bf16 v[48:51], v[208:211], v[224:227], v[48:51]
    v_exp_f32 v140, v140
    v_mfma_f32_16x16x32_bf16 v[52:55], v[212:215], v[224:227], v[52:55]
    v_cvt_pk_bf16_f32 v229, v138, v139
    v_exp_f32 v141, v141
    s_waitcnt lgkmcnt(2)
    v_mfma_f32_16x16x32_bf16 v[56:59], v[216:219], v[224:227], v[56:59]
    v_exp_f32 v142, v142
    s_waitcnt lgkmcnt(0)
    v_mfma_f32_16x16x32_bf16 v[60:63], v[220:223], v[224:227], v[60:63]
    v_cvt_pk_bf16_f32 v230, v140, v141
    v_exp_f32 v143, v143
    v_mfma_f32_16x16x32_bf16 v[232:235], v[244:247], v[224:227], v[232:235]
    ds_read_b64_tr_b16 v[160:161], v8 offset:0
    ds_read_b64_tr_b16 v[162:163], v8 offset:4096
    v_cvt_pk_bf16_f32 v231, v142, v143
    v_max3_f32 v6, v144, v145, v146
    v_max3_f32 v6, v6, v147, v148
    v_mfma_f32_16x16x32_bf16 v[64:67], v[192:195], v[228:231], v[64:67]
    ds_read_b64_tr_b16 v[164:165], v9 offset:0
    ds_read_b64_tr_b16 v[166:167], v9 offset:4096
    ds_read_b64_tr_b16 v[168:169], v10 offset:0
    ds_read_b64_tr_b16 v[170:171], v10 offset:4096
    v_mfma_f32_16x16x32_bf16 v[68:71], v[196:199], v[228:231], v[68:71]
    ds_read_b64_tr_b16 v[172:173], v11 offset:0
    ds_read_b64_tr_b16 v[174:175], v11 offset:4096
    v_max3_f32 v6, v6, v149, v150
    v_mfma_f32_16x16x32_bf16 v[72:75], v[200:203], v[228:231], v[72:75]
    ds_read_b64_tr_b16 v[176:177], v8 offset:1024
    ds_read_b64_tr_b16 v[178:179], v8 offset:5120
    v_max3_f32 v6, v6, v151, v152
    v_mfma_f32_16x16x32_bf16 v[76:79], v[204:207], v[228:231], v[76:79]
    ds_read_b64_tr_b16 v[180:181], v9 offset:1024
    ds_read_b64_tr_b16 v[182:183], v9 offset:5120
    v_max3_f32 v6, v6, v153, v154
    v_mfma_f32_16x16x32_bf16 v[80:83], v[208:211], v[228:231], v[80:83]
    ds_read_b64_tr_b16 v[184:185], v10 offset:1024
    ds_read_b64_tr_b16 v[186:187], v10 offset:5120
    v_max3_f32 v6, v6, v155, v156
    v_mfma_f32_16x16x32_bf16 v[84:87], v[212:215], v[228:231], v[84:87]
    ds_read_b64_tr_b16 v[188:189], v11 offset:1024
    ds_read_b64_tr_b16 v[190:191], v11 offset:5120
    v_max3_f32 v6, v6, v157, v158
    v_mfma_f32_16x16x32_bf16 v[88:91], v[216:219], v[228:231], v[88:91]
    v_max_f32 v6, v6, v159
    v_mfma_f32_16x16x32_bf16 v[92:95], v[220:223], v[228:231], v[92:95]
    v_cmp_lt_f32 vcc, s52, v6
    v_mfma_f32_16x16x32_bf16 v[236:239], v[244:247], v[228:231], v[236:239]
    s_cbranch_vccnz L_resccd
L_backcd:
    v_exp_f32 v144, v144
    v_exp_f32 v145, v145
    v_exp_f32 v146, v146
    v_exp_f32 v147, v147
    v_exp_f32 v148, v148
    v_exp_f32 v149, v149
    v_exp_f32 v150, v150
    v_exp_f32 v151, v151
    v_exp_f32 v152, v152
    v_exp_f32 v153, v153
    v_exp_f32 v154, v154
    v_exp_f32 v155, v155
    v_exp_f32 v156, v156
    v_exp_f32 v157, v157
    v_exp_f32 v158, v158
    v_exp_f32 v159, v159
    v_cvt_pk_bf16_f32 v224, v144, v145
    v_cvt_pk_bf16_f32 v225, v146, v147
    v_cvt_pk_bf16_f32 v226, v148, v149
    v_cvt_pk_bf16_f32 v227, v150, v151
    v_cvt_pk_bf16_f32 v228, v152, v153
    v_cvt_pk_bf16_f32 v229, v154, v155
    v_cvt_pk_bf16_f32 v230, v156, v157
    v_cvt_pk_bf16_f32 v231, v158, v159
    v_mfma_f32_16x16x32_bf16 v[232:235], v[244:247], v[224:227], v[232:235]
    s_nop 0
    v_mfma_f32_16x16x32_bf16 v[236:239], v[244:247], v[228:231], v[236:239]
    s_waitcnt vmcnt(0)
    v_readlane_b32 s43, v243, 0
    v_mov_b32 v24, 1
    s_add_u32 s45, s49, 4096
    v_cmp_eq_u32 vcc, s43, v243
    s_nop 0
    s_and_b32 s43, vcc_lo, 15
    s_cmp_eq_u32 s43, 15
    s_cselect_b32 s59, s49, 0x40000000
    s_add_u32 s60, s59, 4096
    v_rcp_f32 v232, v232
    v_rcp_f32 v236, v236
    v_pk_mul_f32 v[144:145], v[144:145], v[232:233] op_sel_hi:[1,0]
    v_pk_mul_f32 v[146:147], v[146:147], v[232:233] op_sel_hi:[1,0]
    v_pk_mul_f32 v[148:149], v[148:149], v[232:233] op_sel_hi:[1,0]
    v_pk_mul_f32 v[150:151], v[150:151], v[232:233] op_sel_hi:[1,0]
    v_pk_mul_f32 v[152:153], v[152:153], v[236:237] op_sel_hi:[1,0]
    v_pk_mul_f32 v[154:155], v[154:155], v[236:237] op_sel_hi:[1,0]
    v_pk_mul_f32 v[156:157], v[156:157], v[236:237] op_sel_hi:[1,0]
    v_pk_mul_f32 v[158:159], v[158:159], v[236:237] op_sel_hi:[1,0]
    v_pk_mul_f32 v[32:33], v[32:33], v[232:233] op_sel_hi:[1,0]
    v_pk_mul_f32 v[34:35], v[34:35], v[232:233] op_sel_hi:[1,0]
    v_pk_mul_f32 v[36:37], v[36:37], v[232:233] op_sel_hi:[1,0]
    v_pk_mul_f32 v[38:39], v[38:39], v[232:233] op_sel_hi:[1,0]
    v_pk_mul_f32 v[40:41], v[40:41], v[232:233] op_sel_hi:[1,0]
    v_pk_mul_f32 v[42:43], v[42:43], v[232:233] op_sel_hi:[1,0]
    v_pk_mul_f32 v[44:45], v[44:45], v[232:233] op_sel_hi:[1,0]
    v_pk_mul_f32 v[46:47], v[46:47], v[232:233] op_sel_hi:[1,0]
    v_pk_mul_f32 v[48:49], v[48:49], v[232:233] op_sel_hi:[1,0]
    v_pk_mul_f32 v[50:51], v[50:51], v[232:233] op_sel_hi:[1,0]
    v_pk_mul_f32 v[52:53], v[52:53], v[232:233] op_sel_hi:[1,0]
    v_pk_mul_f32 v[54:55], v[54:55], v[232:233] op_sel_hi:[1,0]
    v_pk_mul_f32 v[56:57], v[56:57], v[232:233] op_sel_hi:[1,0]
    v_pk_mul_f32 v[58:59], v[58:59], v[232:233] op_sel_hi:[1,0]
    v_pk_mul_f32 v[60:61], v[60:61], v[232:233] op_sel_hi:[1,0]
    v_pk_mul_f32 v[62:63], v[62:63], v[232:233] op_sel_hi:[1,0]
    v_pk_mul_f32 v[64:65], v[64:65], v[236:237] op_sel_hi:[1,0]
    v_pk_mul_f32 v[66:67], v[66:67], v[236:237] op_sel_hi:[1,0]
    v_pk_mul_f32 v[68:69], v[68:69], v[236:237] op_sel_hi:[1,0]
    v_pk_mul_f32 v[70:71], v[70:71], v[236:237] op_sel_hi:[1,0]
    v_pk_mul_f32 v[72:73], v[72:73], v[236:237] op_sel_hi:[1,0]
    v_pk_mul_f32 v[74:75], v[74:75], v[236:237] op_sel_hi:[1,0]
    v_pk_mul_f32 v[76:77], v[76:77], v[236:237] op_sel_hi:[1,0]
    v_pk_mul_f32 v[78:79], v[78:79], v[236:237] op_sel_hi:[1,0]
    v_pk_mul_f32 v[80:81], v[80:81], v[236:237] op_sel_hi:[1,0]
    v_pk_mul_f32 v[82:83], v[82:83], v[236:237] op_sel_hi:[1,0]
    v_pk_mul_f32 v[84:85], v[84:85], v[236:237] op_sel_hi:[1,0]
    v_pk_mul_f32 v[86:87], v[86:87], v[236:237] op_sel_hi:[1,0]
    v_pk_mul_f32 v[88:89], v[88:89], v[236:237] op_sel_hi:[1,0]
    v_pk_mul_f32 v[90:91], v[90:91], v[236:237] op_sel_hi:[1,0]
    v_pk_mul_f32 v[92:93], v[92:93], v[236:237] op_sel_hi:[1,0]
    v_pk_mul_f32 v[94:95], v[94:95], v[236:237] op_sel_hi:[1,0]
    v_cvt_pk_bf16_f32 v224, v144, v145
    v_cvt_pk_bf16_f32 v225, v146, v147
    v_cvt_pk_bf16_f32 v226, v148, v149
    v_cvt_pk_bf16_f32 v227, v150, v151
    v_cvt_pk_bf16_f32 v228, v152, v153
    v_cvt_pk_bf16_f32 v229, v154, v155
    v_cvt_pk_bf16_f32 v230, v156, v157
    v_cvt_pk_bf16_f32 v231, v158, v159
    s_waitcnt lgkmcnt(0)
    s_barrier
    ds_read_b64_tr_b16 v[192:193], v16 offset:8192
    ds_read_b64_tr_b16 v[194:195], v16 offset:12288
    ds_read_b64_tr_b16 v[196:197], v17 offset:8192
    ds_read_b64_tr_b16 v[198:199], v17 offset:12288
    ds_read_b64_tr_b16 v[200:201], v18 offset:8192
    ds_read_b64_tr_b16 v[202:203], v18 offset:12288
    ds_read_b64_tr_b16 v[204:205], v19 offset:8192
    ds_read_b64_tr_b16 v[206:207], v19 offset:12288
    s_waitcnt lgkmcnt(6)
    v_mfma_f32_16x16x32_bf16 v[32:35], v[192:195], v[224:227], v[32:35]
    ds_read_b64_tr_b16 v[208:209], v20 offset:8192
    ds_read_b64_tr_b16 v[210:211], v20 offset:12288
    v_mfma_f32_16x16x32_bf16 v[64:67], v[192:195], v[228:231], v[64:67]
    ds_read_b64_tr_b16 v[212:213], v21 offset:8192
    ds_read_b64_tr_b16 v[214:215], v21 offset:12288
    s_waitcnt lgkmcnt(8)
    v_mfma_f32_16x16x32_bf16 v[36:39], v[196:199], v[224:227], v[36:39]
    ds_read_b64_tr_b16 v[216:217], v22 offset:8192
    ds_read_b64_tr_b16 v[218:219], v22 offset:12288
    v_mfma_f32_16x16x32_bf16 v[68:71], v[196:199], v[228:231], v[68:71]
    ds_read_b64_tr_b16 v[220:221], v23 offset:8192
    ds_read_b64_tr_b16 v[222:223], v23 offset:12288
    s_waitcnt lgkmcnt(10)
    v_mfma_f32_16x16x32_bf16 v[40:43], v[200:203], v[224:227], v[40:43]
    v_mfma_f32_16x16x32_bf16 v[72:75], v[200:203], v[228:231], v[72:75]
    s_waitcnt lgkmcnt(8)
    v_mfma_f32_16x16x32_bf16 v[44:47], v[204:207], v[224:227], v[44:47]
    v_cvt_pk_bf16_f32 v96, v32, v33
    v_cvt_pk_bf16_f32 v97, v34, v35
    v_mfma_f32_16x16x32_bf16 v[76:79], v[204:207], v[228:231], v[76:79]
    v_cvt_pk_bf16_f32 v98, v36, v37
    v_cvt_pk_bf16_f32 v99, v38, v39
    s_waitcnt lgkmcnt(6)
    v_mfma_f32_16x16x32_bf16 v[48:51], v[208:211], v[224:227], v[48:51]
    v_cvt_pk_bf16_f32 v112, v64, v65
    v_cvt_pk_bf16_f32 v113, v66, v67
    v_mfma_f32_16x16x32_bf16 v[80:83], v[208:211], v[228:231], v[80:83]
    v_cvt_pk_bf16_f32 v114, v68, v69
    v_cvt_pk_bf16_f32 v115, v70, v71
    s_waitcnt lgkmcnt(4)
    v_mfma_f32_16x16x32_bf16 v[52:55], v[212:215], v[224:227], v[52:55]
    v_cvt_pk_bf16_f32 v100, v40, v41
    v_cvt_pk_bf16_f32 v101, v42, v43
    v_permlane16_swap_b32 v96, v112
    v_mfma_f32_16x16x32_bf16 v[84:87], v[212:215], v[228:231], v[84:87]
    v_cvt_pk_bf16_f32 v102, v44, v45
    v_cvt_pk_bf16_f32 v103, v46, v47
    v_permlane16_swap_b32 v97, v113
    s_waitcnt lgkmcnt(2)
    v_mfma_f32_16x16x32_bf16 v[56:59], v[216:219], v[224:227], v[56:59]
    v_cvt_pk_bf16_f32 v116, v72, v73
    v_cvt_pk_bf16_f32 v117, v74, v75
    v_permlane16_swap_b32 v98, v114
    v_mfma_f32_16x16x32_bf16 v[88:91], v[216:219], v[228:231], v[88:91]
    v_cvt_pk_bf16_f32 v118, v76, v77
    v_cvt_pk_bf16_f32 v119, v78, v79
    v_permlane16_swap_b32 v99, v115
    s_waitcnt lgkmcnt(0)
    v_mfma_f32_16x16x32_bf16 v[60:63], v[220:223], v[224:227], v[60:63]
    v_cvt_pk_bf16_f32 v104, v48, v49
    v_cvt_pk_bf16_f32 v105, v50, v51
    v_cvt_pk_bf16_f32 v106, v52, v53
    v_mfma_f32_16x16x32_bf16 v[92:95], v[220:223], v[228:231], v[92:95]
    v_cvt_pk_bf16_f32 v107, v54, v55
    v_cvt_pk_bf16_f32 v120, v80, v81
    v_cvt_pk_bf16_f32 v121, v82, v83
    v_cvt_pk_bf16_f32 v122, v84, v85
    v_cvt_pk_bf16_f32 v123, v86, v87
    buffer_store_dwordx4 v[96:99], v4, s[28:31], s59 offen offset:0
    buffer_store_dwordx4 v[112:115], v4, s[28:31], s59 offen offset:1024
    v_permlane16_swap_b32 v100, v116
    v_permlane16_swap_b32 v101, v117
    v_permlane16_swap_b32 v102, v118
    v_permlane16_swap_b32 v103, v119
    buffer_store_dwordx4 v[100:103], v4, s[28:31], s59 offen offset:2048
    buffer_store_dwordx4 v[116:119], v4, s[28:31], s59 offen offset:3072
    v_permlane16_swap_b32 v104, v120
    v_permlane16_swap_b32 v105, v121
    v_permlane16_swap_b32 v106, v122
    v_permlane16_swap_b32 v107, v123
    v_cvt_pk_bf16_f32 v108, v56, v57
    v_cvt_pk_bf16_f32 v109, v58, v59
    v_cvt_pk_bf16_f32 v110, v60, v61
    v_cvt_pk_bf16_f32 v111, v62, v63
    v_cvt_pk_bf16_f32 v124, v88, v89
    v_cvt_pk_bf16_f32 v125, v90, v91
    v_cvt_pk_bf16_f32 v126, v92, v93
    v_cvt_pk_bf16_f32 v127, v94, v95
    buffer_store_dwordx4 v[104:107], v4, s[28:31], s60 offen offset:0
    buffer_store_dwordx4 v[120:123], v4, s[28:31], s60 offen offset:1024
    v_permlane16_swap_b32 v108, v124
    v_permlane16_swap_b32 v109, v125
    v_permlane16_swap_b32 v110, v126
    v_permlane16_swap_b32 v111, v127
    buffer_store_dwordx4 v[108:111], v4, s[28:31], s60 offen offset:2048
    buffer_store_dwordx4 v[124:127], v4, s[28:31], s60 offen offset:3072
L_join:
    s_cmp_lg_u32 s59, 0x40000000
    s_cbranch_scc1 L_pubj
    buffer_store_dwordx4 v[96:99], v4, s[28:31], s49 offen offset:0 sc1
    buffer_store_dwordx4 v[112:115], v4, s[28:31], s49 offen offset:1024 sc1
    buffer_store_dwordx4 v[100:103], v4, s[28:31], s49 offen offset:2048 sc1
    buffer_store_dwordx4 v[116:119], v4, s[28:31], s49 offen offset:3072 sc1
    buffer_store_dwordx4 v[104:107], v4, s[28:31], s45 offen offset:0 sc1
    buffer_store_dwordx4 v[120:123], v4, s[28:31], s45 offen offset:1024 sc1
    buffer_store_dwordx4 v[108:111], v4, s[28:31], s45 offen offset:2048 sc1
    buffer_store_dwordx4 v[124:127], v4, s[28:31], s45 offen offset:3072 sc1
L_pubj:
    buffer_load_dword v6, v3, s[28:31], 0 offen sc1
    v_mfma_f32_32x32x16_bf16 v[32:47], v[160:163], v[96:99], 0
    ds_read_b64_tr_b16 v[192:193], v8 offset:8192
    ds_read_b64_tr_b16 v[194:195], v8 offset:12288
    v_mfma_f32_32x32x16_bf16 v[48:63], v[164:167], v[96:99], 0
    ds_read_b64_tr_b16 v[196:197], v9 offset:8192
    ds_read_b64_tr_b16 v[198:199], v9 offset:12288
    s_lshl_b32 s43, s20, 7
    s_add_u32 s43, s43, 1024
    v_lshl_add_u32 v2, v0, 2, s43
    v_mfma_f32_32x32x16_bf16 v[64:79], v[168:171], v[96:99], 0
    ds_read_b64_tr_b16 v[200:201], v10 offset:8192
    ds_read_b64_tr_b16 v[202:203], v10 offset:12288
    v_lshlrev_b32 v1, 2, v0
    v_xor_b32 v1, s25, v1
    v_lshl_add_u32 v28, v1, 11, v2
    v_mfma_f32_32x32x16_bf16 v[80:95], v[172:175], v[96:99], 0
    ds_read_b64_tr_b16 v[204:205], v11 offset:8192
    ds_read_b64_tr_b16 v[206:207], v11 offset:12288
    s_lshl_b32 s43, s25, 11
    v_add_u32 v2, s43, v2
    v_subrev_u32 v1, 1, v0
    v_mfma_f32_32x32x16_bf16 v[32:47], v[176:179], v[112:115], v[32:47]
    ds_read_b64_tr_b16 v[208:209], v8 offset:9216
    ds_read_b64_tr_b16 v[210:211], v8 offset:13312
    v_cmp_gt_u32 vcc, 7, v1
    v_bfrev_b32 v1, 1
    s_nop 0
    v_mfma_f32_32x32x16_bf16 v[48:63], v[180:183], v[112:115], v[48:63]
    ds_read_b64_tr_b16 v[212:213], v9 offset:9216
    ds_read_b64_tr_b16 v[214:215], v9 offset:13312
    v_cndmask_b32 v2, v1, v2, vcc
    v_cndmask_b32 v28, v1, v28, vcc
    s_barrier
    v_mfma_f32_32x32x16_bf16 v[64:79], v[184:187], v[112:115], v[64:79]
    ds_read_b64_tr_b16 v[216:217], v10 offset:9216
    ds_read_b64_tr_b16 v[218:219], v10 offset:13312
    s_mov_b32 s61, 0x3f80
    s_mov_b32 s62, 0x3f800000
    v_mfma_f32_32x32x16_bf16 v[80:95], v[188:191], v[112:115], v[80:95]
    ds_read_b64_tr_b16 v[220:221], v11 offset:9216
    ds_read_b64_tr_b16 v[222:223], v11 offset:13312
    s_lshl_b32 s43, s23, 8
    s_and_b32 s44, s21, 7
    s_lshl_b32 s44, s44, 5
    s_add_u32 s40, s43, s44
    s_waitcnt lgkmcnt(14)
    v_mfma_f32_32x32x16_bf16 v[32:47], v[192:195], v[100:103], v[32:47]
    ds_read_b64_tr_b16 v[192:193], v8 offset:16384
    ds_read_b64_tr_b16 v[194:195], v8 offset:20480
    s_mul_i32 s43, s22, 114688
    s_add_u32 s32, s14, s43
    s_addc_u32 s33, s15, 0
    s_mov_b32 s34, 114688
    s_mov_b32 s35, 0x20000
    s_waitcnt lgkmcnt(14)
    v_mfma_f32_32x32x16_bf16 v[48:63], v[196:199], v[100:103], v[48:63]
    ds_read_b64_tr_b16 v[196:197], v9 offset:16384
    ds_read_b64_tr_b16 v[198:199], v9 offset:20480
    s_lshl_b32 s43, s22, 2
    s_add_u32 s43, s43, s23
    s_lshl_b32 s43, s43, 18
    s_lshl_b32 s44, s20, 10
    s_waitcnt lgkmcnt(14)
    v_mfma_f32_32x32x16_bf16 v[64:79], v[200:203], v[100:103], v[64:79]
    ds_read_b64_tr_b16 v[200:201], v10 offset:16384
    ds_read_b64_tr_b16 v[202:203], v10 offset:20480
    s_add_u32 s43, s43, s44
    s_add_u32 s50, s43, 9437184
    s_lshl_b32 s44, s21, 15
    s_add_u32 s51, s50, s44
    s_waitcnt lgkmcnt(14)
    v_mfma_f32_32x32x16_bf16 v[80:95], v[204:207], v[100:103], v[80:95]
    ds_read_b64_tr_b16 v[204:205], v11 offset:16384
    ds_read_b64_tr_b16 v[206:207], v11 offset:20480
    s_waitcnt vmcnt(0)
    s_cmp_lg_u32 s59, 0x40000000
    s_cbranch_scc1 L_flgf
    buffer_store_dword v24, v240, s[28:31], 0 offen sc1
    s_branch L_flgj
L_flgf:
    buffer_store_dword v24, v240, s[28:31], 0 offen
L_flgj:
    s_waitcnt lgkmcnt(14)
    v_mfma_f32_32x32x16_bf16 v[32:47], v[208:211], v[116:119], v[32:47]
    ds_read_b64_tr_b16 v[208:209], v8 offset:17408
    ds_read_b64_tr_b16 v[210:211], v8 offset:21504
    s_waitcnt lgkmcnt(14)
    v_mfma_f32_32x32x16_bf16 v[48:63], v[212:215], v[116:119], v[48:63]
    ds_read_b64_tr_b16 v[212:213], v9 offset:17408
    ds_read_b64_tr_b16 v[214:215], v9 offset:21504
    s_waitcnt lgkmcnt(14)
    v_mfma_f32_32x32x16_bf16 v[64:79], v[216:219], v[116:119], v[64:79]
    ds_read_b64_tr_b16 v[216:217], v10 offset:17408
    ds_read_b64_tr_b16 v[218:219], v10 offset:21504
    s_waitcnt lgkmcnt(14)
    v_mfma_f32_32x32x16_bf16 v[80:95], v[220:223], v[116:119], v[80:95]
    ds_read_b64_tr_b16 v[220:221], v11 offset:17408
    ds_read_b64_tr_b16 v[222:223], v11 offset:21504
    s_waitcnt vmcnt(1)
    v_cmp_eq_u32 vcc, 1, v6
    s_mov_b32 s57, 0x40000000
    s_xor_b32 s43, s49, 32768
    s_bitcmp1_b32 vcc_lo, 1
    s_cselect_b32 s57, s43, s57
    s_add_u32 s58, s57, 4096
    s_waitcnt lgkmcnt(14)
    v_mfma_f32_32x32x16_bf16 v[32:47], v[192:195], v[104:107], v[32:47]
    ds_read_b64_tr_b16 v[192:193], v8 offset:24576
    ds_read_b64_tr_b16 v[194:195], v8 offset:28672
    buffer_load_dwordx4 v[128:131], v4, s[28:31], s57 offen offset:0 sc1
    s_waitcnt lgkmcnt(14)
    v_mfma_f32_32x32x16_bf16 v[48:63], v[196:199], v[104:107], v[48:63]
    ds_read_b64_tr_b16 v[196:197], v9 offset:24576
    ds_read_b64_tr_b16 v[198:199], v9 offset:28672
    s_waitcnt lgkmcnt(14)
    v_mfma_f32_32x32x16_bf16 v[64:79], v[200:203], v[104:107], v[64:79]
    ds_read_b64_tr_b16 v[200:201], v10 offset:24576
    ds_read_b64_tr_b16 v[202:203], v10 offset:28672
    v_add_u32 v16, 131072, v12
    buffer_load_dwordx4 v[132:135], v4, s[28:31], s57 offen offset:1024 sc1
    s_waitcnt lgkmcnt(14)
    v_mfma_f32_32x32x16_bf16 v[80:95], v[204:207], v[104:107], v[80:95]
    ds_read_b64_tr_b16 v[204:205], v11 offset:24576
    ds_read_b64_tr_b16 v[206:207], v11 offset:28672
    v_add_u32 v17, 131072, v13
    s_waitcnt lgkmcnt(14)
    v_mfma_f32_32x32x16_bf16 v[32:47], v[208:211], v[120:123], v[32:47]
    ds_read_b64_tr_b16 v[208:209], v8 offset:25600
    ds_read_b64_tr_b16 v[210:211], v8 offset:29696
    v_add_u32 v18, 131072, v14
    buffer_load_dwordx4 v[136:139], v4, s[28:31], s57 offen offset:2048 sc1
    s_waitcnt lgkmcnt(14)
    v_mfma_f32_32x32x16_bf16 v[48:63], v[212:215], v[120:123], v[48:63]
    ds_read_b64_tr_b16 v[212:213], v9 offset:25600
    ds_read_b64_tr_b16 v[214:215], v9 offset:29696
    v_add_u32 v19, 131072, v15
    s_waitcnt lgkmcnt(14)
    v_mfma_f32_32x32x16_bf16 v[64:79], v[216:219], v[120:123], v[64:79]
    ds_read_b64_tr_b16 v[216:217], v10 offset:25600
    ds_read_b64_tr_b16 v[218:219], v10 offset:29696
    buffer_load_dwordx4 v[140:143], v4, s[28:31], s57 offen offset:3072 sc1
    s_waitcnt lgkmcnt(14)
    v_mfma_f32_32x32x16_bf16 v[80:95], v[220:223], v[120:123], v[80:95]
    ds_read_b64_tr_b16 v[220:221], v11 offset:25600
    ds_read_b64_tr_b16 v[222:223], v11 offset:29696
    s_cmp_lg_u32 s57, 0x40000000
    s_cbranch_scc1 L_dec1d
    s_mov_b32 s42, 0x100000
L_dec1:
    buffer_load_dword v6, v3, s[28:31], 0 offen sc1
    s_waitcnt vmcnt(0)
    v_cmp_eq_u32 vcc, 1, v6
    s_mov_b32 s57, 0x40000000
    s_xor_b32 s43, s49, 32768
    s_bitcmp1_b32 vcc_lo, 1
    s_cselect_b32 s57, s43, s57
    s_add_u32 s58, s57, 4096
    s_sub_u32 s42, s42, 1
    s_cbranch_scc1 L_dec1l
    s_cmp_eq_u32 s57, 0x40000000
    s_cbranch_scc1 L_dec1
L_dec1l:
    buffer_load_dwordx4 v[128:131], v4, s[28:31], s57 offen offset:0 sc1
    buffer_load_dwordx4 v[132:135], v4, s[28:31], s57 offen offset:1024 sc1
    buffer_load_dwordx4 v[136:139], v4, s[28:31], s57 offen offset:2048 sc1
    buffer_load_dwordx4 v[140:143], v4, s[28:31], s57 offen offset:3072 sc1
L_dec1d:
    s_waitcnt lgkmcnt(14)
    v_mfma_f32_32x32x16_bf16 v[32:47], v[192:195], v[108:111], v[32:47]
    ds_read_b64_tr_b16 v[192:193], v16 offset:0
    ds_read_b64_tr_b16 v[194:195], v16 offset:4096
    buffer_load_dwordx4 v[144:147], v4, s[28:31], s58 offen offset:0 sc1
    s_waitcnt lgkmcnt(14)
    v_mfma_f32_32x32x16_bf16 v[48:63], v[196:199], v[108:111], v[48:63]
    ds_read_b64_tr_b16 v[196:197], v17 offset:0
    ds_read_b64_tr_b16 v[198:199], v17 offset:4096
    s_waitcnt lgkmcnt(14)
    v_mfma_f32_32x32x16_bf16 v[64:79], v[200:203], v[108:111], v[64:79]
    ds_read_b64_tr_b16 v[200:201], v18 offset:0
    ds_read_b64_tr_b16 v[202:203], v18 offset:4096
    buffer_load_dwordx4 v[148:151], v4, s[28:31], s58 offen offset:1024 sc1
    s_waitcnt lgkmcnt(14)
    v_mfma_f32_32x32x16_bf16 v[80:95], v[204:207], v[108:111], v[80:95]
    ds_read_b64_tr_b16 v[204:205], v19 offset:0
    ds_read_b64_tr_b16 v[206:207], v19 offset:4096
    s_waitcnt lgkmcnt(14)
    v_mfma_f32_32x32x16_bf16 v[32:47], v[208:211], v[124:127], v[32:47]
    ds_read_b64_tr_b16 v[208:209], v16 offset:1024
    ds_read_b64_tr_b16 v[210:211], v16 offset:5120
    buffer_load_dwordx4 v[152:155], v4, s[28:31], s58 offen offset:2048 sc1
    s_waitcnt lgkmcnt(14)
    v_mfma_f32_32x32x16_bf16 v[48:63], v[212:215], v[124:127], v[48:63]
    ds_read_b64_tr_b16 v[212:213], v17 offset:1024
    ds_read_b64_tr_b16 v[214:215], v17 offset:5120
    s_waitcnt lgkmcnt(14)
    v_mfma_f32_32x32x16_bf16 v[64:79], v[216:219], v[124:127], v[64:79]
    ds_read_b64_tr_b16 v[216:217], v18 offset:1024
    ds_read_b64_tr_b16 v[218:219], v18 offset:5120
    buffer_load_dwordx4 v[156:159], v4, s[28:31], s58 offen offset:3072 sc1
    s_waitcnt lgkmcnt(14)
    v_mfma_f32_32x32x16_bf16 v[80:95], v[220:223], v[124:127], v[80:95]
    ds_read_b64_tr_b16 v[220:221], v19 offset:1024
    ds_read_b64_tr_b16 v[222:223], v19 offset:5120
    s_waitcnt vmcnt(7) lgkmcnt(14)
    v_mfma_f32_32x32x16_bf16 v[32:47], v[192:195], v[128:131], v[32:47]
    ds_read_b64_tr_b16 v[192:193], v16 offset:8192
    ds_read_b64_tr_b16 v[194:195], v16 offset:12288
    s_waitcnt lgkmcnt(14)
    v_mfma_f32_32x32x16_bf16 v[48:63], v[196:199], v[128:131], v[48:63]
    ds_read_b64_tr_b16 v[196:197], v17 offset:8192
    ds_read_b64_tr_b16 v[198:199], v17 offset:12288
    s_waitcnt lgkmcnt(14)
    v_mfma_f32_32x32x16_bf16 v[64:79], v[200:203], v[128:131], v[64:79]
    ds_read_b64_tr_b16 v[200:201], v18 offset:8192
    ds_read_b64_tr_b16 v[202:203], v18 offset:12288
    s_waitcnt lgkmcnt(14)
    v_mfma_f32_32x32x16_bf16 v[80:95], v[204:207], v[128:131], v[80:95]
    ds_read_b64_tr_b16 v[204:205], v19 offset:8192
    ds_read_b64_tr_b16 v[206:207], v19 offset:12288
    s_waitcnt vmcnt(6) lgkmcnt(14)
    v_mfma_f32_32x32x16_bf16 v[32:47], v[208:211], v[132:135], v[32:47]
    ds_read_b64_tr_b16 v[208:209], v16 offset:9216
    ds_read_b64_tr_b16 v[210:211], v16 offset:13312
    s_waitcnt lgkmcnt(14)
    v_mfma_f32_32x32x16_bf16 v[48:63], v[212:215], v[132:135], v[48:63]
    ds_read_b64_tr_b16 v[212:213], v17 offset:9216
    ds_read_b64_tr_b16 v[214:215], v17 offset:13312
    s_waitcnt lgkmcnt(14)
    v_mfma_f32_32x32x16_bf16 v[64:79], v[216:219], v[132:135], v[64:79]
    ds_read_b64_tr_b16 v[216:217], v18 offset:9216
    ds_read_b64_tr_b16 v[218:219], v18 offset:13312
    buffer_load_dword v6, v3, s[28:31], 0 offen sc1
    s_waitcnt lgkmcnt(14)
    v_mfma_f32_32x32x16_bf16 v[80:95], v[220:223], v[132:135], v[80:95]
    ds_read_b64_tr_b16 v[220:221], v19 offset:9216
    ds_read_b64_tr_b16 v[222:223], v19 offset:13312
    s_waitcnt vmcnt(6) lgkmcnt(14)
    v_mfma_f32_32x32x16_bf16 v[32:47], v[192:195], v[136:139], v[32:47]
    ds_read_b64_tr_b16 v[192:193], v16 offset:16384
    ds_read_b64_tr_b16 v[194:195], v16 offset:20480
    s_waitcnt lgkmcnt(14)
    v_mfma_f32_32x32x16_bf16 v[48:63], v[196:199], v[136:139], v[48:63]
    ds_read_b64_tr_b16 v[196:197], v17 offset:16384
    ds_read_b64_tr_b16 v[198:199], v17 offset:20480
    s_waitcnt lgkmcnt(14)
    v_mfma_f32_32x32x16_bf16 v[64:79], v[200:203], v[136:139], v[64:79]
    ds_read_b64_tr_b16 v[200:201], v18 offset:16384
    ds_read_b64_tr_b16 v[202:203], v18 offset:20480
    s_waitcnt lgkmcnt(14)
    v_mfma_f32_32x32x16_bf16 v[80:95], v[204:207], v[136:139], v[80:95]
    ds_read_b64_tr_b16 v[204:205], v19 offset:16384
    ds_read_b64_tr_b16 v[206:207], v19 offset:20480
    s_waitcnt vmcnt(5) lgkmcnt(14)
    v_mfma_f32_32x32x16_bf16 v[32:47], v[208:211], v[140:143], v[32:47]
    ds_read_b64_tr_b16 v[208:209], v16 offset:17408
    ds_read_b64_tr_b16 v[210:211], v16 offset:21504
    s_waitcnt lgkmcnt(14)
    v_mfma_f32_32x32x16_bf16 v[48:63], v[212:215], v[140:143], v[48:63]
    ds_read_b64_tr_b16 v[212:213], v17 offset:17408
    ds_read_b64_tr_b16 v[214:215], v17 offset:21504
    s_waitcnt lgkmcnt(14)
    v_mfma_f32_32x32x16_bf16 v[64:79], v[216:219], v[140:143], v[64:79]
    ds_read_b64_tr_b16 v[216:217], v18 offset:17408
    ds_read_b64_tr_b16 v[218:219], v18 offset:21504
    s_waitcnt lgkmcnt(14)
    v_mfma_f32_32x32x16_bf16 v[80:95], v[220:223], v[140:143], v[80:95]
    ds_read_b64_tr_b16 v[220:221], v19 offset:17408
    ds_read_b64_tr_b16 v[222:223], v19 offset:21504
    s_waitcnt vmcnt(0)
    v_cmp_eq_u32 vcc, 1, v6
    s_mov_b32 s57, 0x40000000
    s_xor_b32 s43, s49, 65536
    s_bitcmp1_b32 vcc_lo, 2
    s_cselect_b32 s57, s43, s57
    s_add_u32 s58, s57, 4096
    s_waitcnt lgkmcnt(14)
    v_mfma_f32_32x32x16_bf16 v[32:47], v[192:195], v[144:147], v[32:47]
    ds_read_b64_tr_b16 v[192:193], v16 offset:24576
    ds_read_b64_tr_b16 v[194:195], v16 offset:28672
    buffer_load_dwordx4 v[160:163], v4, s[28:31], s57 offen offset:0 sc1
    s_waitcnt lgkmcnt(14)
    v_mfma_f32_32x32x16_bf16 v[48:63], v[196:199], v[144:147], v[48:63]
    ds_read_b64_tr_b16 v[196:197], v17 offset:24576
    ds_read_b64_tr_b16 v[198:199], v17 offset:28672
    s_waitcnt lgkmcnt(14)
    v_mfma_f32_32x32x16_bf16 v[64:79], v[200:203], v[144:147], v[64:79]
    ds_read_b64_tr_b16 v[200:201], v18 offset:24576
    ds_read_b64_tr_b16 v[202:203], v18 offset:28672
    v_add_u32 v8, 32768, v12
    buffer_load_dwordx4 v[164:167], v4, s[28:31], s57 offen offset:1024 sc1
    s_waitcnt lgkmcnt(14)
    v_mfma_f32_32x32x16_bf16 v[80:95], v[204:207], v[144:147], v[80:95]
    ds_read_b64_tr_b16 v[204:205], v19 offset:24576
    ds_read_b64_tr_b16 v[206:207], v19 offset:28672
    v_add_u32 v9, 32768, v13
    s_waitcnt lgkmcnt(14)
    v_mfma_f32_32x32x16_bf16 v[32:47], v[208:211], v[148:151], v[32:47]
    ds_read_b64_tr_b16 v[208:209], v16 offset:25600
    ds_read_b64_tr_b16 v[210:211], v16 offset:29696
    v_add_u32 v10, 32768, v14
    buffer_load_dwordx4 v[168:171], v4, s[28:31], s57 offen offset:2048 sc1
    s_waitcnt lgkmcnt(14)
    v_mfma_f32_32x32x16_bf16 v[48:63], v[212:215], v[148:151], v[48:63]
    ds_read_b64_tr_b16 v[212:213], v17 offset:25600
    ds_read_b64_tr_b16 v[214:215], v17 offset:29696
    v_add_u32 v11, 32768, v15
    s_waitcnt lgkmcnt(14)
    v_mfma_f32_32x32x16_bf16 v[64:79], v[216:219], v[148:151], v[64:79]
    ds_read_b64_tr_b16 v[216:217], v18 offset:25600
    ds_read_b64_tr_b16 v[218:219], v18 offset:29696
    buffer_load_dwordx4 v[172:175], v4, s[28:31], s57 offen offset:3072 sc1
    s_waitcnt lgkmcnt(14)
    v_mfma_f32_32x32x16_bf16 v[80:95], v[220:223], v[148:151], v[80:95]
    ds_read_b64_tr_b16 v[220:221], v19 offset:25600
    ds_read_b64_tr_b16 v[222:223], v19 offset:29696
    s_cmp_lg_u32 s57, 0x40000000
    s_cbranch_scc1 L_dec2d
    s_mov_b32 s42, 0x100000
L_dec2:
    buffer_load_dword v6, v3, s[28:31], 0 offen sc1
    s_waitcnt vmcnt(0)
    v_cmp_eq_u32 vcc, 1, v6
    s_mov_b32 s57, 0x40000000
    s_xor_b32 s43, s49, 65536
    s_bitcmp1_b32 vcc_lo, 2
    s_cselect_b32 s57, s43, s57
    s_add_u32 s58, s57, 4096
    s_sub_u32 s42, s42, 1
    s_cbranch_scc1 L_dec2l
    s_cmp_eq_u32 s57, 0x40000000
    s_cbranch_scc1 L_dec2
L_dec2l:
    buffer_load_dwordx4 v[160:163], v4, s[28:31], s57 offen offset:0 sc1
    buffer_load_dwordx4 v[164:167], v4, s[28:31], s57 offen offset:1024 sc1
    buffer_load_dwordx4 v[168:171], v4, s[28:31], s57 offen offset:2048 sc1
    buffer_load_dwordx4 v[172:175], v4, s[28:31], s57 offen offset:3072 sc1
L_dec2d:
    s_waitcnt lgkmcnt(14)
    v_mfma_f32_32x32x16_bf16 v[32:47], v[192:195], v[152:155], v[32:47]
    ds_read_b64_tr_b16 v[192:193], v8 offset:0
    ds_read_b64_tr_b16 v[194:195], v8 offset:4096
    buffer_load_dwordx4 v[176:179], v4, s[28:31], s58 offen offset:0 sc1
    s_waitcnt lgkmcnt(14)
    v_mfma_f32_32x32x16_bf16 v[48:63], v[196:199], v[152:155], v[48:63]
    ds_read_b64_tr_b16 v[196:197], v9 offset:0
    ds_read_b64_tr_b16 v[198:199], v9 offset:4096
    s_waitcnt lgkmcnt(14)
    v_mfma_f32_32x32x16_bf16 v[64:79], v[200:203], v[152:155], v[64:79]
    ds_read_b64_tr_b16 v[200:201], v10 offset:0
    ds_read_b64_tr_b16 v[202:203], v10 offset:4096
    buffer_load_dwordx4 v[180:183], v4, s[28:31], s58 offen offset:1024 sc1
    s_waitcnt lgkmcnt(14)
    v_mfma_f32_32x32x16_bf16 v[80:95], v[204:207], v[152:155], v[80:95]
    ds_read_b64_tr_b16 v[204:205], v11 offset:0
    ds_read_b64_tr_b16 v[206:207], v11 offset:4096
    s_waitcnt lgkmcnt(14)
    v_mfma_f32_32x32x16_bf16 v[32:47], v[208:211], v[156:159], v[32:47]
    ds_read_b64_tr_b16 v[208:209], v8 offset:1024
    ds_read_b64_tr_b16 v[210:211], v8 offset:5120
    buffer_load_dwordx4 v[184:187], v4, s[28:31], s58 offen offset:2048 sc1
    s_waitcnt lgkmcnt(14)
    v_mfma_f32_32x32x16_bf16 v[48:63], v[212:215], v[156:159], v[48:63]
    ds_read_b64_tr_b16 v[212:213], v9 offset:1024
    ds_read_b64_tr_b16 v[214:215], v9 offset:5120
    s_waitcnt lgkmcnt(14)
    v_mfma_f32_32x32x16_bf16 v[64:79], v[216:219], v[156:159], v[64:79]
    ds_read_b64_tr_b16 v[216:217], v10 offset:1024
    ds_read_b64_tr_b16 v[218:219], v10 offset:5120
    buffer_load_dwordx4 v[188:191], v4, s[28:31], s58 offen offset:3072 sc1
    buffer_load_dword v6, v3, s[28:31], 0 offen sc1
    s_waitcnt lgkmcnt(14)
    v_mfma_f32_32x32x16_bf16 v[80:95], v[220:223], v[156:159], v[80:95]
    ds_read_b64_tr_b16 v[220:221], v11 offset:1024
    ds_read_b64_tr_b16 v[222:223], v11 offset:5120
    s_waitcnt vmcnt(8) lgkmcnt(14)
    v_mfma_f32_32x32x16_bf16 v[32:47], v[192:195], v[160:163], v[32:47]
    ds_read_b64_tr_b16 v[192:193], v8 offset:8192
    ds_read_b64_tr_b16 v[194:195], v8 offset:12288
    s_waitcnt lgkmcnt(14)
    v_mfma_f32_32x32x16_bf16 v[48:63], v[196:199], v[160:163], v[48:63]
    ds_read_b64_tr_b16 v[196:197], v9 offset:8192
    ds_read_b64_tr_b16 v[198:199], v9 offset:12288
    s_waitcnt lgkmcnt(14)
    v_mfma_f32_32x32x16_bf16 v[64:79], v[200:203], v[160:163], v[64:79]
    ds_read_b64_tr_b16 v[200:201], v10 offset:8192
    ds_read_b64_tr_b16 v[202:203], v10 offset:12288
    s_waitcnt lgkmcnt(14)
    v_mfma_f32_32x32x16_bf16 v[80:95], v[204:207], v[160:163], v[80:95]
    ds_read_b64_tr_b16 v[204:205], v11 offset:8192
    ds_read_b64_tr_b16 v[206:207], v11 offset:12288
    s_waitcnt vmcnt(7) lgkmcnt(14)
    v_mfma_f32_32x32x16_bf16 v[32:47], v[208:211], v[164:167], v[32:47]
    ds_read_b64_tr_b16 v[208:209], v8 offset:9216
    ds_read_b64_tr_b16 v[210:211], v8 offset:13312
    s_waitcnt lgkmcnt(14)
    v_mfma_f32_32x32x16_bf16 v[48:63], v[212:215], v[164:167], v[48:63]
    ds_read_b64_tr_b16 v[212:213], v9 offset:9216
    ds_read_b64_tr_b16 v[214:215], v9 offset:13312
    s_waitcnt lgkmcnt(14)
    v_mfma_f32_32x32x16_bf16 v[64:79], v[216:219], v[164:167], v[64:79]
    ds_read_b64_tr_b16 v[216:217], v10 offset:9216
    ds_read_b64_tr_b16 v[218:219], v10 offset:13312
    s_waitcnt lgkmcnt(14)
    v_mfma_f32_32x32x16_bf16 v[80:95], v[220:223], v[164:167], v[80:95]
    ds_read_b64_tr_b16 v[220:221], v11 offset:9216
    ds_read_b64_tr_b16 v[222:223], v11 offset:13312
    s_waitcnt vmcnt(0)
    v_cmp_eq_u32 vcc, 1, v6
    s_mov_b32 s57, 0x40000000
    s_xor_b32 s43, s49, 98304
    s_bitcmp1_b32 vcc_lo, 3
    s_cselect_b32 s57, s43, s57
    s_add_u32 s58, s57, 4096
    s_waitcnt lgkmcnt(14)
    v_mfma_f32_32x32x16_bf16 v[32:47], v[192:195], v[168:171], v[32:47]
    ds_read_b64_tr_b16 v[192:193], v8 offset:16384
    ds_read_b64_tr_b16 v[194:195], v8 offset:20480
    buffer_load_dwordx4 v[224:227], v4, s[28:31], s57 offen offset:0 sc1
    s_waitcnt lgkmcnt(14)
    v_mfma_f32_32x32x16_bf16 v[48:63], v[196:199], v[168:171], v[48:63]
    ds_read_b64_tr_b16 v[196:197], v9 offset:16384
    ds_read_b64_tr_b16 v[198:199], v9 offset:20480
    s_waitcnt lgkmcnt(14)
    v_mfma_f32_32x32x16_bf16 v[64:79], v[200:203], v[168:171], v[64:79]
    ds_read_b64_tr_b16 v[200:201], v10 offset:16384
    ds_read_b64_tr_b16 v[202:203], v10 offset:20480
    buffer_load_dwordx4 v[228:231], v4, s[28:31], s57 offen offset:1024 sc1
    s_waitcnt lgkmcnt(14)
    v_mfma_f32_32x32x16_bf16 v[80:95], v[204:207], v[168:171], v[80:95]
    ds_read_b64_tr_b16 v[204:205], v11 offset:16384
    ds_read_b64_tr_b16 v[206:207], v11 offset:20480
    s_waitcnt lgkmcnt(14)
    v_mfma_f32_32x32x16_bf16 v[32:47], v[208:211], v[172:175], v[32:47]
    ds_read_b64_tr_b16 v[208:209], v8 offset:17408
    ds_read_b64_tr_b16 v[210:211], v8 offset:21504
    buffer_load_dwordx4 v[232:235], v4, s[28:31], s57 offen offset:2048 sc1
    s_waitcnt lgkmcnt(14)
    v_mfma_f32_32x32x16_bf16 v[48:63], v[212:215], v[172:175], v[48:63]
    ds_read_b64_tr_b16 v[212:213], v9 offset:17408
    ds_read_b64_tr_b16 v[214:215], v9 offset:21504
    s_waitcnt lgkmcnt(14)
    v_mfma_f32_32x32x16_bf16 v[64:79], v[216:219], v[172:175], v[64:79]
    ds_read_b64_tr_b16 v[216:217], v10 offset:17408
    ds_read_b64_tr_b16 v[218:219], v10 offset:21504
    buffer_load_dwordx4 v[236:239], v4, s[28:31], s57 offen offset:3072 sc1
    s_waitcnt lgkmcnt(14)
    v_mfma_f32_32x32x16_bf16 v[80:95], v[220:223], v[172:175], v[80:95]
    ds_read_b64_tr_b16 v[220:221], v11 offset:17408
    ds_read_b64_tr_b16 v[222:223], v11 offset:21504
    s_waitcnt lgkmcnt(14)
    v_mfma_f32_32x32x16_bf16 v[32:47], v[192:195], v[176:179], v[32:47]
    ds_read_b64_tr_b16 v[192:193], v8 offset:24576
    ds_read_b64_tr_b16 v[194:195], v8 offset:28672
    buffer_load_dwordx4 v[240:243], v4, s[28:31], s58 offen offset:0 sc1
    s_waitcnt lgkmcnt(14)
    v_mfma_f32_32x32x16_bf16 v[48:63], v[196:199], v[176:179], v[48:63]
    ds_read_b64_tr_b16 v[196:197], v9 offset:24576
    ds_read_b64_tr_b16 v[198:199], v9 offset:28672
    s_waitcnt lgkmcnt(14)
    v_mfma_f32_32x32x16_bf16 v[64:79], v[200:203], v[176:179], v[64:79]
    ds_read_b64_tr_b16 v[200:201], v10 offset:24576
    ds_read_b64_tr_b16 v[202:203], v10 offset:28672
    v_mov_b32 v16, v12
    buffer_load_dwordx4 v[244:247], v4, s[28:31], s58 offen offset:1024 sc1
    s_waitcnt lgkmcnt(14)
    v_mfma_f32_32x32x16_bf16 v[80:95], v[204:207], v[176:179], v[80:95]
    ds_read_b64_tr_b16 v[204:205], v11 offset:24576
    ds_read_b64_tr_b16 v[206:207], v11 offset:28672
    v_mov_b32 v17, v13
    s_waitcnt lgkmcnt(14)
    v_mfma_f32_32x32x16_bf16 v[32:47], v[208:211], v[180:183], v[32:47]
    ds_read_b64_tr_b16 v[208:209], v8 offset:25600
    ds_read_b64_tr_b16 v[210:211], v8 offset:29696
    v_mov_b32 v18, v14
    buffer_load_dwordx4 v[248:251], v4, s[28:31], s58 offen offset:2048 sc1
    s_waitcnt lgkmcnt(14)
    v_mfma_f32_32x32x16_bf16 v[48:63], v[212:215], v[180:183], v[48:63]
    ds_read_b64_tr_b16 v[212:213], v9 offset:25600
    ds_read_b64_tr_b16 v[214:215], v9 offset:29696
    v_mov_b32 v19, v15
    s_waitcnt lgkmcnt(14)
    v_mfma_f32_32x32x16_bf16 v[64:79], v[216:219], v[180:183], v[64:79]
    ds_read_b64_tr_b16 v[216:217], v10 offset:25600
    ds_read_b64_tr_b16 v[218:219], v10 offset:29696
    buffer_load_dwordx4 v[252:255], v4, s[28:31], s58 offen offset:3072 sc1
    s_waitcnt lgkmcnt(14)
    v_mfma_f32_32x32x16_bf16 v[80:95], v[220:223], v[180:183], v[80:95]
    ds_read_b64_tr_b16 v[220:221], v11 offset:25600
    ds_read_b64_tr_b16 v[222:223], v11 offset:29696
    s_cmp_lg_u32 s57, 0x40000000
    s_cbranch_scc1 L_dec3d
    s_mov_b32 s42, 0x100000
L_dec3:
    buffer_load_dword v6, v3, s[28:31], 0 offen sc1
    s_waitcnt vmcnt(0)
    v_cmp_eq_u32 vcc, 1, v6
    s_mov_b32 s57, 0x40000000
    s_xor_b32 s43, s49, 98304
    s_bitcmp1_b32 vcc_lo, 3
    s_cselect_b32 s57, s43, s57
    s_add_u32 s58, s57, 4096
    s_sub_u32 s42, s42, 1
    s_cbranch_scc1 L_dec3l
    s_cmp_eq_u32 s57, 0x40000000
    s_cbranch_scc1 L_dec3
L_dec3l:
    buffer_load_dwordx4 v[224:227], v4, s[28:31], s57 offen offset:0 sc1
    buffer_load_dwordx4 v[228:231], v4, s[28:31], s57 offen offset:1024 sc1
    buffer_load_dwordx4 v[232:235], v4, s[28:31], s57 offen offset:2048 sc1
    buffer_load_dwordx4 v[236:239], v4, s[28:31], s57 offen offset:3072 sc1
    buffer_load_dwordx4 v[240:243], v4, s[28:31], s58 offen offset:0 sc1
    buffer_load_dwordx4 v[244:247], v4, s[28:31], s58 offen offset:1024 sc1
    buffer_load_dwordx4 v[248:251], v4, s[28:31], s58 offen offset:2048 sc1
    buffer_load_dwordx4 v[252:255], v4, s[28:31], s58 offen offset:3072 sc1
L_dec3d:
    s_waitcnt lgkmcnt(14)
    v_mfma_f32_32x32x16_bf16 v[32:47], v[192:195], v[184:187], v[32:47]
    ds_read_b64_tr_b16 v[192:193], v17 offset:0
    ds_read_b64_tr_b16 v[194:195], v17 offset:4096
    s_waitcnt lgkmcnt(14)
    v_mfma_f32_32x32x16_bf16 v[48:63], v[196:199], v[184:187], v[48:63]
    ds_read_b64_tr_b16 v[196:197], v17 offset:1024
    ds_read_b64_tr_b16 v[198:199], v17 offset:5120
    s_waitcnt lgkmcnt(14)
    v_mfma_f32_32x32x16_bf16 v[64:79], v[200:203], v[184:187], v[64:79]
    ds_read_b64_tr_b16 v[200:201], v17 offset:8192
    ds_read_b64_tr_b16 v[202:203], v17 offset:12288
    s_waitcnt lgkmcnt(14)
    v_mfma_f32_32x32x16_bf16 v[80:95], v[204:207], v[184:187], v[80:95]
    ds_read_b64_tr_b16 v[204:205], v17 offset:9216
    ds_read_b64_tr_b16 v[206:207], v17 offset:13312
    s_waitcnt lgkmcnt(14)
    v_mfma_f32_32x32x16_bf16 v[32:47], v[208:211], v[188:191], v[32:47]
    ds_read_b64_tr_b16 v[208:209], v17 offset:16384
    ds_read_b64_tr_b16 v[210:211], v17 offset:20480
    s_waitcnt lgkmcnt(14)
    v_mfma_f32_32x32x16_bf16 v[48:63], v[212:215], v[188:191], v[48:63]
    ds_read_b64_tr_b16 v[212:213], v17 offset:17408
    ds_read_b64_tr_b16 v[214:215], v17 offset:21504
    s_waitcnt lgkmcnt(14)
    v_mfma_f32_32x32x16_bf16 v[64:79], v[216:219], v[188:191], v[64:79]
    ds_read_b64_tr_b16 v[216:217], v17 offset:24576
    ds_read_b64_tr_b16 v[218:219], v17 offset:28672
    s_waitcnt lgkmcnt(14)
    v_mfma_f32_32x32x16_bf16 v[80:95], v[220:223], v[188:191], v[80:95]
    ds_read_b64_tr_b16 v[220:221], v17 offset:25600
    ds_read_b64_tr_b16 v[222:223], v17 offset:29696
    s_waitcnt vmcnt(7) lgkmcnt(14)
    v_mfma_f32_32x32x16_bf16 v[48:63], v[192:195], v[224:227], v[48:63]
    ds_read_b64_tr_b16 v[192:193], v18 offset:0
    ds_read_b64_tr_b16 v[194:195], v18 offset:4096
    s_waitcnt vmcnt(6) lgkmcnt(14)
    v_mfma_f32_32x32x16_bf16 v[48:63], v[196:199], v[228:231], v[48:63]
    ds_read_b64_tr_b16 v[196:197], v18 offset:1024
    ds_read_b64_tr_b16 v[198:199], v18 offset:5120
    s_waitcnt vmcnt(5) lgkmcnt(14)
    v_mfma_f32_32x32x16_bf16 v[48:63], v[200:203], v[232:235], v[48:63]
    ds_read_b64_tr_b16 v[200:201], v18 offset:8192
    ds_read_b64_tr_b16 v[202:203], v18 offset:12288
    s_waitcnt vmcnt(4) lgkmcnt(14)
    v_mfma_f32_32x32x16_bf16 v[48:63], v[204:207], v[236:239], v[48:63]
    ds_read_b64_tr_b16 v[204:205], v18 offset:9216
    ds_read_b64_tr_b16 v[206:207], v18 offset:13312
    s_waitcnt vmcnt(3) lgkmcnt(14)
    v_mfma_f32_32x32x16_bf16 v[48:63], v[208:211], v[240:243], v[48:63]
    ds_read_b64_tr_b16 v[208:209], v18 offset:16384
    ds_read_b64_tr_b16 v[210:211], v18 offset:20480
    s_waitcnt vmcnt(2) lgkmcnt(14)
    v_mfma_f32_32x32x16_bf16 v[48:63], v[212:215], v[244:247], v[48:63]
    ds_read_b64_tr_b16 v[212:213], v18 offset:17408
    ds_read_b64_tr_b16 v[214:215], v18 offset:21504
    s_waitcnt vmcnt(1) lgkmcnt(14)
    v_mfma_f32_32x32x16_bf16 v[48:63], v[216:219], v[248:251], v[48:63]
    ds_read_b64_tr_b16 v[216:217], v18 offset:24576
    ds_read_b64_tr_b16 v[218:219], v18 offset:28672
    s_waitcnt vmcnt(0) lgkmcnt(14)
    v_mfma_f32_32x32x16_bf16 v[48:63], v[220:223], v[252:255], v[48:63]
    ds_read_b64_tr_b16 v[220:221], v18 offset:25600
    ds_read_b64_tr_b16 v[222:223], v18 offset:29696
    s_waitcnt lgkmcnt(14)
    v_mfma_f32_32x32x16_bf16 v[64:79], v[192:195], v[224:227], v[64:79]
    ds_read_b64_tr_b16 v[192:193], v19 offset:0
    ds_read_b64_tr_b16 v[194:195], v19 offset:4096
    s_waitcnt lgkmcnt(14)
    v_mfma_f32_32x32x16_bf16 v[64:79], v[196:199], v[228:231], v[64:79]
    ds_read_b64_tr_b16 v[196:197], v19 offset:1024
    ds_read_b64_tr_b16 v[198:199], v19 offset:5120
    s_waitcnt lgkmcnt(14)
    v_mfma_f32_32x32x16_bf16 v[64:79], v[200:203], v[232:235], v[64:79]
    ds_read_b64_tr_b16 v[200:201], v19 offset:8192
    ds_read_b64_tr_b16 v[202:203], v19 offset:12288
    s_xor_b32 s43, s21, 2
    s_lshl_b32 s43, s43, 15
    s_add_u32 s43, s43, s50
    s_add_u32 s43, s43, 8192
    s_waitcnt lgkmcnt(14)
    v_mfma_f32_32x32x16_bf16 v[64:79], v[204:207], v[236:239], v[64:79]
    ds_read_b64_tr_b16 v[204:205], v19 offset:9216
    ds_read_b64_tr_b16 v[206:207], v19 offset:13312
    v_cvt_pk_bf16_f32 v48, v48, v49
    v_cvt_pk_bf16_f32 v49, v50, v51
    v_cvt_pk_bf16_f32 v50, v52, v53
    v_cvt_pk_bf16_f32 v51, v54, v55
    s_waitcnt lgkmcnt(14)
    v_mfma_f32_32x32x16_bf16 v[64:79], v[208:211], v[240:243], v[64:79]
    ds_read_b64_tr_b16 v[208:209], v19 offset:16384
    ds_read_b64_tr_b16 v[210:211], v19 offset:20480
    buffer_store_dwordx4 v[48:51], v4, s[28:31], s43 offen sc1
    s_waitcnt lgkmcnt(14)
    v_mfma_f32_32x32x16_bf16 v[64:79], v[212:215], v[244:247], v[64:79]
    ds_read_b64_tr_b16 v[212:213], v19 offset:17408
    ds_read_b64_tr_b16 v[214:215], v19 offset:21504
    s_xor_b32 s43, s21, 3
    s_lshl_b32 s43, s43, 15
    s_add_u32 s43, s43, s50
    s_add_u32 s43, s43, 12288
    s_waitcnt lgkmcnt(14)
    v_mfma_f32_32x32x16_bf16 v[64:79], v[216:219], v[248:251], v[64:79]
    ds_read_b64_tr_b16 v[216:217], v19 offset:24576
    ds_read_b64_tr_b16 v[218:219], v19 offset:28672
    v_cvt_pk_bf16_f32 v56, v56, v57
    v_cvt_pk_bf16_f32 v57, v58, v59
    v_cvt_pk_bf16_f32 v58, v60, v61
    v_cvt_pk_bf16_f32 v59, v62, v63
    s_waitcnt lgkmcnt(14)
    v_mfma_f32_32x32x16_bf16 v[64:79], v[220:223], v[252:255], v[64:79]
    ds_read_b64_tr_b16 v[220:221], v19 offset:25600
    ds_read_b64_tr_b16 v[222:223], v19 offset:29696
    buffer_store_dwordx4 v[56:59], v4, s[28:31], s43 offen sc1
    s_waitcnt lgkmcnt(14)
    v_mfma_f32_32x32x16_bf16 v[80:95], v[192:195], v[224:227], v[80:95]
    ds_read_b64_tr_b16 v[192:193], v16 offset:0
    ds_read_b64_tr_b16 v[194:195], v16 offset:4096
    s_waitcnt lgkmcnt(14)
    v_mfma_f32_32x32x16_bf16 v[80:95], v[196:199], v[228:231], v[80:95]
    ds_read_b64_tr_b16 v[196:197], v16 offset:1024
    ds_read_b64_tr_b16 v[198:199], v16 offset:5120
    s_waitcnt lgkmcnt(14)
    v_mfma_f32_32x32x16_bf16 v[80:95], v[200:203], v[232:235], v[80:95]
    ds_read_b64_tr_b16 v[200:201], v16 offset:8192
    ds_read_b64_tr_b16 v[202:203], v16 offset:12288
    s_xor_b32 s43, s21, 4
    s_lshl_b32 s43, s43, 15
    s_add_u32 s43, s43, s50
    s_add_u32 s43, s43, 16384
    s_waitcnt lgkmcnt(14)
    v_mfma_f32_32x32x16_bf16 v[80:95], v[204:207], v[236:239], v[80:95]
    ds_read_b64_tr_b16 v[204:205], v16 offset:9216
    ds_read_b64_tr_b16 v[206:207], v16 offset:13312
    v_cvt_pk_bf16_f32 v64, v64, v65
    v_cvt_pk_bf16_f32 v65, v66, v67
    v_cvt_pk_bf16_f32 v66, v68, v69
    v_cvt_pk_bf16_f32 v67, v70, v71
    s_waitcnt lgkmcnt(14)
    v_mfma_f32_32x32x16_bf16 v[80:95], v[208:211], v[240:243], v[80:95]
    ds_read_b64_tr_b16 v[208:209], v16 offset:16384
    ds_read_b64_tr_b16 v[210:211], v16 offset:20480
    buffer_store_dwordx4 v[64:67], v4, s[28:31], s43 offen sc1
    s_waitcnt lgkmcnt(14)
    v_mfma_f32_32x32x16_bf16 v[80:95], v[212:215], v[244:247], v[80:95]
    ds_read_b64_tr_b16 v[212:213], v16 offset:17408
    ds_read_b64_tr_b16 v[214:215], v16 offset:21504
    s_xor_b32 s43, s21, 5
    s_lshl_b32 s43, s43, 15
    s_add_u32 s43, s43, s50
    s_add_u32 s43, s43, 20480
    s_waitcnt lgkmcnt(14)
    v_mfma_f32_32x32x16_bf16 v[80:95], v[216:219], v[248:251], v[80:95]
    ds_read_b64_tr_b16 v[216:217], v16 offset:24576
    ds_read_b64_tr_b16 v[218:219], v16 offset:28672
    v_cvt_pk_bf16_f32 v72, v72, v73
    v_cvt_pk_bf16_f32 v73, v74, v75
    v_cvt_pk_bf16_f32 v74, v76, v77
    v_cvt_pk_bf16_f32 v75, v78, v79
    s_waitcnt lgkmcnt(14)
    v_mfma_f32_32x32x16_bf16 v[80:95], v[220:223], v[252:255], v[80:95]
    ds_read_b64_tr_b16 v[220:221], v16 offset:25600
    ds_read_b64_tr_b16 v[222:223], v16 offset:29696
    buffer_store_dwordx4 v[72:75], v4, s[28:31], s43 offen sc1
    s_waitcnt lgkmcnt(14)
    v_mfma_f32_32x32x16_bf16 v[32:47], v[192:195], v[224:227], v[32:47]
    s_waitcnt lgkmcnt(12)
    v_mfma_f32_32x32x16_bf16 v[32:47], v[196:199], v[228:231], v[32:47]
    s_waitcnt lgkmcnt(10)
    v_mfma_f32_32x32x16_bf16 v[32:47], v[200:203], v[232:235], v[32:47]
    s_xor_b32 s43, s21, 6
    s_lshl_b32 s43, s43, 15
    s_add_u32 s43, s43, s50
    s_add_u32 s43, s43, 24576
    s_waitcnt lgkmcnt(8)
    v_mfma_f32_32x32x16_bf16 v[32:47], v[204:207], v[236:239], v[32:47]
    v_cvt_pk_bf16_f32 v80, v80, v81
    v_cvt_pk_bf16_f32 v81, v82, v83
    v_cvt_pk_bf16_f32 v82, v84, v85
    v_cvt_pk_bf16_f32 v83, v86, v87
    s_waitcnt lgkmcnt(6)
    v_mfma_f32_32x32x16_bf16 v[32:47], v[208:211], v[240:243], v[32:47]
    buffer_store_dwordx4 v[80:83], v4, s[28:31], s43 offen sc1
    s_waitcnt lgkmcnt(4)
    v_mfma_f32_32x32x16_bf16 v[32:47], v[212:215], v[244:247], v[32:47]
    s_xor_b32 s43, s21, 7
    s_lshl_b32 s43, s43, 15
    s_add_u32 s43, s43, s50
    s_add_u32 s43, s43, 28672
    s_waitcnt lgkmcnt(2)
    v_mfma_f32_32x32x16_bf16 v[32:47], v[216:219], v[248:251], v[32:47]
    v_cvt_pk_bf16_f32 v88, v88, v89
    v_cvt_pk_bf16_f32 v89, v90, v91
    v_cvt_pk_bf16_f32 v90, v92, v93
    v_cvt_pk_bf16_f32 v91, v94, v95
    s_waitcnt lgkmcnt(0)
    v_mfma_f32_32x32x16_bf16 v[32:47], v[220:223], v[252:255], v[32:47]
    buffer_store_dwordx4 v[88:91], v4, s[28:31], s43 offen sc1
    s_xor_b32 s43, s21, 1
    s_lshl_b32 s43, s43, 15
    s_add_u32 s43, s43, s50
    s_add_u32 s43, s43, 4096
    s_nop 6
    v_cvt_pk_bf16_f32 v40, v40, v41
    v_cvt_pk_bf16_f32 v41, v42, v43
    v_cvt_pk_bf16_f32 v42, v44, v45
    v_cvt_pk_bf16_f32 v43, v46, v47
    buffer_store_dwordx4 v[40:43], v4, s[28:31], s43 offen sc1
    buffer_load_dword v6, v2, s[28:31], 0 offen sc1
    s_waitcnt vmcnt(1)
    buffer_store_dword v24, v28, s[28:31], 0 offen sc1
    buffer_load_dword v29, v2, s[28:31], 0 offen sc1
    s_mov_b32 s42, 0x100000
    s_waitcnt vmcnt(2)
L_poll2:
    v_cmp_eq_u32 vcc, 1, v6
    s_nop 0
    s_cmp_eq_u32 vcc_lo, 0xfe
    s_cbranch_scc1 L_poll2e
    buffer_load_dword v6, v2, s[28:31], 0 offen sc1
    s_waitcnt vmcnt(1)
    s_waitcnt vmcnt(0)
    v_cmp_eq_u32 vcc, 1, v29
    s_nop 0
    s_cmp_eq_u32 vcc_lo, 0xfe
    s_cbranch_scc1 L_poll2e
    buffer_load_dword v29, v2, s[28:31], 0 offen sc1
    s_sub_u32 s42, s42, 1
    s_waitcnt vmcnt(1)
    s_cbranch_scc0 L_poll2
L_poll2e:
    s_add_u32 s53, s51, 4096
    buffer_load_dwordx4 v[96:99], v4, s[28:31], s53 offen sc1
    s_add_u32 s53, s51, 8192
    buffer_load_dwordx4 v[100:103], v4, s[28:31], s53 offen sc1
    s_add_u32 s53, s51, 12288
    buffer_load_dwordx4 v[104:107], v4, s[28:31], s53 offen sc1
    s_add_u32 s53, s51, 16384
    buffer_load_dwordx4 v[108:111], v4, s[28:31], s53 offen sc1
    s_add_u32 s53, s51, 20480
    buffer_load_dwordx4 v[112:115], v4, s[28:31], s53 offen sc1
    s_add_u32 s53, s51, 24576
    buffer_load_dwordx4 v[116:119], v4, s[28:31], s53 offen sc1
    s_add_u32 s53, s51, 28672
    buffer_load_dwordx4 v[120:123], v4, s[28:31], s53 offen sc1
    s_waitcnt vmcnt(6)
    v_dot2_f32_bf16 v32, v96, s61, v32
    v_dot2_f32_bf16 v33, v96, s62, v33
    v_dot2_f32_bf16 v34, v97, s61, v34
    v_dot2_f32_bf16 v35, v97, s62, v35
    v_dot2_f32_bf16 v36, v98, s61, v36
    v_dot2_f32_bf16 v37, v98, s62, v37
    v_dot2_f32_bf16 v38, v99, s61, v38
    v_dot2_f32_bf16 v39, v99, s62, v39
    s_waitcnt vmcnt(5)
    v_dot2_f32_bf16 v32, v100, s61, v32
    v_dot2_f32_bf16 v33, v100, s62, v33
    v_dot2_f32_bf16 v34, v101, s61, v34
    v_dot2_f32_bf16 v35, v101, s62, v35
    v_dot2_f32_bf16 v36, v102, s61, v36
    v_dot2_f32_bf16 v37, v102, s62, v37
    v_dot2_f32_bf16 v38, v103, s61, v38
    v_dot2_f32_bf16 v39, v103, s62, v39
    s_waitcnt vmcnt(4)
    v_dot2_f32_bf16 v32, v104, s61, v32
    v_dot2_f32_bf16 v33, v104, s62, v33
    v_dot2_f32_bf16 v34, v105, s61, v34
    v_dot2_f32_bf16 v35, v105, s62, v35
    v_dot2_f32_bf16 v36, v106, s61, v36
    v_dot2_f32_bf16 v37, v106, s62, v37
    v_dot2_f32_bf16 v38, v107, s61, v38
    v_dot2_f32_bf16 v39, v107, s62, v39
    s_waitcnt vmcnt(3)
    v_dot2_f32_bf16 v32, v108, s61, v32
    v_dot2_f32_bf16 v33, v108, s62, v33
    v_dot2_f32_bf16 v34, v109, s61, v34
    v_dot2_f32_bf16 v35, v109, s62, v35
    v_dot2_f32_bf16 v36, v110, s61, v36
    v_dot2_f32_bf16 v37, v110, s62, v37
    v_dot2_f32_bf16 v38, v111, s61, v38
    v_dot2_f32_bf16 v39, v111, s62, v39
    s_waitcnt vmcnt(2)
    v_dot2_f32_bf16 v32, v112, s61, v32
    v_dot2_f32_bf16 v33, v112, s62, v33
    v_dot2_f32_bf16 v34, v113, s61, v34
    v_dot2_f32_bf16 v35, v113, s62, v35
    v_dot2_f32_bf16 v36, v114, s61, v36
    v_dot2_f32_bf16 v37, v114, s62, v37
    v_dot2_f32_bf16 v38, v115, s61, v38
    v_dot2_f32_bf16 v39, v115, s62, v39
    s_waitcnt vmcnt(1)
    v_dot2_f32_bf16 v32, v116, s61, v32
    v_dot2_f32_bf16 v33, v116, s62, v33
    v_dot2_f32_bf16 v34, v117, s61, v34
    v_dot2_f32_bf16 v35, v117, s62, v35
    v_dot2_f32_bf16 v36, v118, s61, v36
    v_dot2_f32_bf16 v37, v118, s62, v37
    v_dot2_f32_bf16 v38, v119, s61, v38
    v_dot2_f32_bf16 v39, v119, s62, v39
    s_waitcnt vmcnt(0)
    v_dot2_f32_bf16 v32, v120, s61, v32
    v_dot2_f32_bf16 v33, v120, s62, v33
    v_dot2_f32_bf16 v34, v121, s61, v34
    v_dot2_f32_bf16 v35, v121, s62, v35
    v_dot2_f32_bf16 v36, v122, s61, v36
    v_dot2_f32_bf16 v37, v122, s62, v37
    v_dot2_f32_bf16 v38, v123, s61, v38
    v_dot2_f32_bf16 v39, v123, s62, v39
    s_nop 2
    v_cvt_pk_bf16_f32 v40, v32, v33
    v_cvt_pk_bf16_f32 v41, v34, v35
    v_cvt_pk_bf16_f32 v42, v36, v37
    v_cvt_pk_bf16_f32 v43, v38, v39
    buffer_store_dwordx4 v[40:43], v7, s[32:35], s40 offen
L_end:
    s_endpgm
L_paths:
    s_barrier
    ds_read_b128 v[224:227], v104 offset:0
    ds_read_b64_tr_b16 v[192:193], v96 offset:0
    ds_read_b64_tr_b16 v[194:195], v96 offset:1024
    ds_read_b64_tr_b16 v[196:197], v97 offset:0
    ds_read_b64_tr_b16 v[198:199], v97 offset:1024
    ds_read_b64_tr_b16 v[200:201], v98 offset:0
    ds_read_b64_tr_b16 v[202:203], v98 offset:1024
    ds_read_b64_tr_b16 v[204:205], v99 offset:0
    ds_read_b64_tr_b16 v[206:207], v99 offset:1024
    ds_read_b64_tr_b16 v[208:209], v100 offset:0
    ds_read_b64_tr_b16 v[210:211], v100 offset:1024
    ds_read_b64_tr_b16 v[212:213], v101 offset:0
    ds_read_b64_tr_b16 v[214:215], v101 offset:1024
    ds_read_b64_tr_b16 v[216:217], v102 offset:0
    ds_read_b64_tr_b16 v[218:219], v102 offset:1024
    ds_read_b64_tr_b16 v[220:221], v103 offset:0
    ds_read_b64_tr_b16 v[222:223], v103 offset:1024
L_qs:
    s_waitcnt lgkmcnt(14)
    v_mfma_f32_16x16x32_bf16 v[32:35], v[192:195], v[224:227], v[32:35]
    ds_read_b128 v[232:235], v105 offset:0
    ds_read_b64_tr_b16 v[128:129], v96 offset:8192
    s_and_b32 s48, s45, 7
    s_lshr_b32 s45, s45, 3
    s_waitcnt lgkmcnt(14)
    v_mfma_f32_16x16x32_bf16 v[36:39], v[196:199], v[224:227], v[36:39]
    ds_read_b64_tr_b16 v[130:131], v96 offset:9216
    ds_read_b64_tr_b16 v[132:133], v97 offset:8192
    ds_read_b64_tr_b16 v[134:135], v97 offset:9216
    s_sub_u32 s48, s48, 3
    s_lshl_b32 s48, s48, 15
    s_waitcnt lgkmcnt(15)
    v_mfma_f32_16x16x32_bf16 v[40:43], v[200:203], v[224:227], v[40:43]
    ds_read_b64_tr_b16 v[136:137], v98 offset:8192
    ds_read_b64_tr_b16 v[138:139], v98 offset:9216
    ds_read_b64_tr_b16 v[140:141], v99 offset:8192
    s_waitcnt lgkmcnt(15)
    v_mfma_f32_16x16x32_bf16 v[44:47], v[204:207], v[224:227], v[44:47]
    ds_read_b64_tr_b16 v[142:143], v99 offset:9216
    ds_read_b64_tr_b16 v[144:145], v100 offset:8192
    s_waitcnt lgkmcnt(15)
    v_mfma_f32_16x16x32_bf16 v[48:51], v[208:211], v[224:227], v[48:51]
    ds_read_b64_tr_b16 v[146:147], v100 offset:9216
    ds_read_b64_tr_b16 v[148:149], v101 offset:8192
    s_waitcnt lgkmcnt(15)
    v_mfma_f32_16x16x32_bf16 v[52:55], v[212:215], v[224:227], v[52:55]
    ds_read_b64_tr_b16 v[150:151], v101 offset:9216
    ds_read_b64_tr_b16 v[152:153], v102 offset:8192
    s_waitcnt lgkmcnt(15)
    v_mfma_f32_16x16x32_bf16 v[56:59], v[216:219], v[224:227], v[56:59]
    ds_read_b64_tr_b16 v[154:155], v102 offset:9216
    ds_read_b64_tr_b16 v[156:157], v103 offset:8192
    s_waitcnt lgkmcnt(15)
    v_mfma_f32_16x16x32_bf16 v[60:63], v[220:223], v[224:227], v[60:63]
    ds_read_b64_tr_b16 v[158:159], v103 offset:9216
    s_cmp_lg_u32 s42, 3
    s_cbranch_scc1 L_qnbs
    s_barrier
L_qnbs:
    s_waitcnt lgkmcnt(14)
    v_mfma_f32_16x16x32_bf16 v[32:35], v[128:131], v[232:235], v[32:35]
    v_add_u32 v96, s48, v96
    v_add_u32 v97, s48, v97
    v_add_u32 v98, s48, v98
    v_add_u32 v99, s48, v99
    s_waitcnt lgkmcnt(12)
    v_mfma_f32_16x16x32_bf16 v[36:39], v[132:135], v[232:235], v[36:39]
    v_add_u32 v100, s48, v100
    v_add_u32 v101, s48, v101
    v_add_u32 v102, s48, v102
    v_add_u32 v103, s48, v103
    s_waitcnt lgkmcnt(10)
    v_mfma_f32_16x16x32_bf16 v[40:43], v[136:139], v[232:235], v[40:43]
    v_add_u32 v104, s48, v104
    v_add_u32 v105, s48, v105
    s_waitcnt lgkmcnt(0)
    s_barrier
    v_mfma_f32_16x16x32_bf16 v[44:47], v[140:143], v[232:235], v[44:47]
    ds_read_b128 v[224:227], v104 offset:0
    ds_read_b64_tr_b16 v[192:193], v96 offset:0
    ds_read_b64_tr_b16 v[194:195], v96 offset:1024
    v_mfma_f32_16x16x32_bf16 v[48:51], v[144:147], v[232:235], v[48:51]
    ds_read_b64_tr_b16 v[196:197], v97 offset:0
    ds_read_b64_tr_b16 v[198:199], v97 offset:1024
    ds_read_b64_tr_b16 v[200:201], v98 offset:0
    ds_read_b64_tr_b16 v[202:203], v98 offset:1024
    v_mfma_f32_16x16x32_bf16 v[52:55], v[148:151], v[232:235], v[52:55]
    ds_read_b64_tr_b16 v[204:205], v99 offset:0
    ds_read_b64_tr_b16 v[206:207], v99 offset:1024
    ds_read_b64_tr_b16 v[208:209], v100 offset:0
    ds_read_b64_tr_b16 v[210:211], v100 offset:1024
    v_mfma_f32_16x16x32_bf16 v[56:59], v[152:155], v[232:235], v[56:59]
    ds_read_b64_tr_b16 v[212:213], v101 offset:0
    ds_read_b64_tr_b16 v[214:215], v101 offset:1024
    ds_read_b64_tr_b16 v[216:217], v102 offset:0
    ds_read_b64_tr_b16 v[218:219], v102 offset:1024
    v_mfma_f32_16x16x32_bf16 v[60:63], v[156:159], v[232:235], v[60:63]
    ds_read_b64_tr_b16 v[220:221], v103 offset:0
    ds_read_b64_tr_b16 v[222:223], v103 offset:1024
    s_sub_u32 s42, s42, 1
    s_cmp_lg_u32 s42, 0
    s_cbranch_scc1 L_qs
    s_waitcnt lgkmcnt(0)
    ds_read_b128 v[160:163], v8 offset:0
    ds_read_b128 v[176:179], v8 offset:4096
    ds_read_b128 v[164:167], v9 offset:0
    ds_read_b128 v[180:183], v9 offset:4096
    ds_read_b128 v[168:171], v10 offset:0
    ds_read_b128 v[184:187], v10 offset:4096
    ds_read_b128 v[172:175], v11 offset:0
    ds_read_b128 v[188:191], v11 offset:4096
    s_waitcnt vmcnt(0)
    v_pk_mul_f32 v[32:33], v[32:33], s[46:47]
    v_pk_mul_f32 v[34:35], v[34:35], s[46:47]
    v_pk_mul_f32 v[36:37], v[36:37], s[46:47]
    v_pk_mul_f32 v[38:39], v[38:39], s[46:47]
    v_cvt_pk_bf16_f32 v96, v32, v33
    v_cvt_pk_bf16_f32 v97, v34, v35
    v_cvt_pk_bf16_f32 v98, v36, v37
    v_cvt_pk_bf16_f32 v99, v38, v39
    s_nop 0
    v_permlane16_swap_b32 v96, v98
    v_permlane16_swap_b32 v97, v99
    v_mov_b32 v232, 0
    v_mov_b32 v233, 0
    v_mov_b32 v234, 0
    v_mov_b32 v235, 0
    s_waitcnt lgkmcnt(7)
    v_mfma_f32_16x16x32_bf16 v[128:131], v[160:163], v[96:99], 0
    v_mul_f32 v40, s46, v40
    v_mul_f32 v41, s46, v41
    v_mul_f32 v42, s46, v42
    v_mul_f32 v43, s46, v43
    v_mul_f32 v44, s46, v44
    v_mul_f32 v45, s46, v45
    v_mul_f32 v46, s46, v46
    s_waitcnt lgkmcnt(6)
    v_mfma_f32_16x16x32_bf16 v[132:135], v[176:179], v[96:99], 0
    ds_read_b128 v[160:163], v8 offset:8192
    v_mul_f32 v47, s46, v47
    v_cvt_pk_bf16_f32 v100, v40, v41
    v_cvt_pk_bf16_f32 v101, v42, v43
    v_cvt_pk_bf16_f32 v102, v44, v45
    v_cvt_pk_bf16_f32 v103, v46, v47
    s_nop 0
    v_permlane16_swap_b32 v100, v102
    v_permlane16_swap_b32 v101, v103
    s_waitcnt lgkmcnt(6)
    s_nop 0
    v_mfma_f32_16x16x32_bf16 v[128:131], v[164:167], v[100:103], v[128:131]
    ds_read_b128 v[176:179], v8 offset:12288
    v_mul_f32 v48, s46, v48
    v_mul_f32 v49, s46, v49
    v_mul_f32 v50, s46, v50
    v_mul_f32 v51, s46, v51
    v_mul_f32 v52, s46, v52
    v_mul_f32 v53, s46, v53
    v_mul_f32 v54, s46, v54
    s_waitcnt lgkmcnt(6)
    v_mfma_f32_16x16x32_bf16 v[132:135], v[180:183], v[100:103], v[132:135]
    ds_read_b128 v[164:167], v9 offset:8192
    v_mul_f32 v55, s46, v55
    v_cvt_pk_bf16_f32 v104, v48, v49
    v_cvt_pk_bf16_f32 v105, v50, v51
    v_cvt_pk_bf16_f32 v106, v52, v53
    v_cvt_pk_bf16_f32 v107, v54, v55
    s_nop 0
    v_permlane16_swap_b32 v104, v106
    v_permlane16_swap_b32 v105, v107
    s_waitcnt lgkmcnt(6)
    s_nop 0
    v_mfma_f32_16x16x32_bf16 v[128:131], v[168:171], v[104:107], v[128:131]
    ds_read_b128 v[180:183], v9 offset:12288
    v_mul_f32 v56, s46, v56
    v_mul_f32 v57, s46, v57
    v_mul_f32 v58, s46, v58
    v_mul_f32 v59, s46, v59
    v_mul_f32 v60, s46, v60
    v_mul_f32 v61, s46, v61
    v_mul_f32 v62, s46, v62
    s_waitcnt lgkmcnt(6)
    v_mfma_f32_16x16x32_bf16 v[132:135], v[184:187], v[104:107], v[132:135]
    ds_read_b128 v[168:171], v10 offset:8192
    v_mul_f32 v63, s46, v63
    v_cvt_pk_bf16_f32 v108, v56, v57
    v_cvt_pk_bf16_f32 v109, v58, v59
    v_cvt_pk_bf16_f32 v110, v60, v61
    v_cvt_pk_bf16_f32 v111, v62, v63
    s_nop 0
    v_permlane16_swap_b32 v108, v110
    v_permlane16_swap_b32 v109, v111
    s_waitcnt lgkmcnt(6)
    s_nop 0
    v_mfma_f32_16x16x32_bf16 v[128:131], v[172:175], v[108:111], v[128:131]
    ds_read_b128 v[184:187], v10 offset:12288
    v_mov_b32 v236, 0
    v_mov_b32 v237, 0
    v_mov_b32 v238, 0
    v_mov_b32 v239, 0
    s_waitcnt lgkmcnt(6)
    v_mfma_f32_16x16x32_bf16 v[132:135], v[188:191], v[108:111], v[132:135]
    ds_read_b128 v[172:175], v11 offset:8192
    v_mov_b32 v244, 0x3f803f80
    v_mov_b32 v245, 0x3f803f80
    v_mov_b32 v246, 0x3f803f80
    v_mov_b32 v247, 0x3f803f80
    v_mfma_f32_32x32x16_bf16 v[32:47], v[232:235], v[232:235], 0
    ds_read_b128 v[188:191], v11 offset:12288
    v_mfma_f32_32x32x16_bf16 v[48:63], v[232:235], v[232:235], 0
    v_add_u32 v8, 16384, v8
    v_add_u32 v9, 16384, v9
    v_add_u32 v10, 16384, v10
    v_add_u32 v11, 16384, v11
    v_mov_b32 v112, 0
    v_mov_b32 v113, 0
    v_mov_b32 v114, 0
    v_mov_b32 v115, 0
    v_mov_b32 v116, 0
    v_mov_b32 v117, 0
    v_mov_b32 v118, 0
    v_mov_b32 v119, 0
    v_mov_b32 v120, 0
    v_mov_b32 v121, 0
    v_mov_b32 v122, 0
    v_mov_b32 v123, 0
    v_mov_b32 v124, 0
    v_mov_b32 v125, 0
    v_mov_b32 v126, 0
    v_mov_b32 v127, 0
    v_max3_f32 v1, v128, v129, v130
    v_max3_f32 v1, v1, v131, v132
    v_max3_f32 v1, v1, v133, v134
    v_max_f32 v1, v1, v135
    v_mov_b32 v2, v1
    s_nop 1
    v_permlane32_swap_b32 v2, v1
    v_max_f32 v1, v2, v1
    v_mov_b32 v2, v1
    s_nop 1
    v_permlane16_swap_b32 v2, v1
    v_max_f32 v1, v2, v1
    v_sub_f32 v24, 0, v1
    v_mov_b32 v25, v24
    v_mov_b32 v26, v24
    v_mov_b32 v27, v24
    v_add_f32 v128, v128, v24
    v_add_f32 v129, v129, v24
    v_add_f32 v130, v130, v24
    v_add_f32 v131, v131, v24
    v_add_f32 v132, v132, v24
    v_add_f32 v133, v133, v24
    v_add_f32 v134, v134, v24
    v_add_f32 v135, v135, v24
    s_mov_b32 s54, 0x27773cf3
    s_mov_b32 s55, 0x1ddf3cf3
    s_mov_b32 s42, 15
L_atts:
    s_waitcnt lgkmcnt(0)
    s_barrier
    v_mfma_f32_16x16x32_bf16 v[144:147], v[160:163], v[96:99], v[24:27]
    v_exp_f32 v128, v128
    ds_read_b64_tr_b16 v[192:193], v16 offset:0
    ds_read_b64_tr_b16 v[194:195], v16 offset:4096
    v_mfma_f32_16x16x32_bf16 v[148:151], v[176:179], v[96:99], v[24:27]
    v_exp_f32 v129, v129
    ds_read_b64_tr_b16 v[196:197], v17 offset:0
    v_cvt_pk_bf16_f32 v224, v128, v129
    v_mfma_f32_16x16x32_bf16 v[144:147], v[164:167], v[100:103], v[144:147]
    v_exp_f32 v130, v130
    ds_read_b64_tr_b16 v[198:199], v17 offset:4096
    ds_read_b64_tr_b16 v[200:201], v18 offset:0
    v_mfma_f32_16x16x32_bf16 v[148:151], v[180:183], v[100:103], v[148:151]
    v_exp_f32 v131, v131
    ds_read_b64_tr_b16 v[202:203], v18 offset:4096
    v_cvt_pk_bf16_f32 v225, v130, v131
    v_mfma_f32_16x16x32_bf16 v[144:147], v[168:171], v[104:107], v[144:147]
    v_exp_f32 v132, v132
    ds_read_b64_tr_b16 v[204:205], v19 offset:0
    ds_read_b64_tr_b16 v[206:207], v19 offset:4096
    v_mfma_f32_16x16x32_bf16 v[148:151], v[184:187], v[104:107], v[148:151]
    v_exp_f32 v133, v133
    ds_read_b64_tr_b16 v[208:209], v20 offset:0
    v_cvt_pk_bf16_f32 v226, v132, v133
    v_mfma_f32_16x16x32_bf16 v[144:147], v[172:175], v[108:111], v[144:147]
    v_exp_f32 v134, v134
    ds_read_b64_tr_b16 v[210:211], v20 offset:4096
    v_exp_f32 v135, v135
    v_mfma_f32_16x16x32_bf16 v[148:151], v[188:191], v[108:111], v[148:151]
    ds_read_b64_tr_b16 v[212:213], v21 offset:0
    v_cvt_pk_bf16_f32 v227, v134, v135
    ds_read_b64_tr_b16 v[214:215], v21 offset:4096
    s_waitcnt lgkmcnt(4)
    v_mfma_f32_16x16x32_bf16 v[32:35], v[192:195], v[224:227], v[32:35]
    ds_read_b64_tr_b16 v[216:217], v22 offset:0
    ds_read_b64_tr_b16 v[218:219], v22 offset:4096
    v_mfma_f32_16x16x32_bf16 v[36:39], v[196:199], v[224:227], v[36:39]
    ds_read_b64_tr_b16 v[220:221], v23 offset:0
    v_mfma_f32_16x16x32_bf16 v[40:43], v[200:203], v[224:227], v[40:43]
    ds_read_b64_tr_b16 v[222:223], v23 offset:4096
    v_mfma_f32_16x16x32_bf16 v[44:47], v[204:207], v[224:227], v[44:47]
    s_waitcnt lgkmcnt(4)
    v_mfma_f32_16x16x32_bf16 v[48:51], v[208:211], v[224:227], v[48:51]
    v_mfma_f32_16x16x32_bf16 v[52:55], v[212:215], v[224:227], v[52:55]
    s_waitcnt lgkmcnt(2)
    v_mfma_f32_16x16x32_bf16 v[56:59], v[216:219], v[224:227], v[56:59]
    s_waitcnt lgkmcnt(0)
    v_mfma_f32_16x16x32_bf16 v[60:63], v[220:223], v[224:227], v[60:63]
    v_mfma_f32_16x16x32_bf16 v[232:235], v[244:247], v[224:227], v[232:235]
    ds_read_b128 v[160:163], v8 offset:0
    v_max3_f32 v6, v144, v145, v146
    v_max3_f32 v6, v6, v147, v148
    ds_read_b128 v[176:179], v8 offset:4096
    ds_read_b128 v[164:167], v9 offset:0
    ds_read_b128 v[180:183], v9 offset:4096
    v_max3_f32 v6, v6, v149, v150
    ds_read_b128 v[168:171], v10 offset:0
    v_max_f32 v6, v6, v151
    ds_read_b128 v[184:187], v10 offset:4096
    ds_read_b128 v[172:175], v11 offset:0
    ds_read_b128 v[188:191], v11 offset:4096
    v_cmp_lt_f32 vcc, s52, v6
    s_nop 0
    s_cbranch_vccnz L_rescas
L_backas:
    s_waitcnt lgkmcnt(0)
    s_barrier
    s_cmp_lg_u32 s42, 1
    s_cbranch_scc1 L_noinfos
    buffer_load_dword v243, v242, s[28:31], 0 offen sc1
L_noinfos:
    v_mfma_f32_16x16x32_bf16 v[128:131], v[160:163], v[96:99], v[24:27]
    v_exp_f32 v144, v144
    ds_read_b64_tr_b16 v[192:193], v16 offset:8192
    ds_read_b64_tr_b16 v[194:195], v16 offset:12288
    s_and_b32 s56, s55, 3
    s_lshr_b32 s55, s55, 2
    v_mfma_f32_16x16x32_bf16 v[132:135], v[176:179], v[96:99], v[24:27]
    v_exp_f32 v145, v145
    ds_read_b64_tr_b16 v[196:197], v17 offset:8192
    v_cvt_pk_bf16_f32 v224, v144, v145
    s_sub_u32 s56, s56, 2
    s_lshl_b32 s56, s56, 14
    v_mfma_f32_16x16x32_bf16 v[128:131], v[164:167], v[100:103], v[128:131]
    v_exp_f32 v146, v146
    ds_read_b64_tr_b16 v[198:199], v17 offset:12288
    ds_read_b64_tr_b16 v[200:201], v18 offset:8192
    s_and_b32 s48, s54, 3
    s_lshr_b32 s54, s54, 2
    v_mfma_f32_16x16x32_bf16 v[132:135], v[180:183], v[100:103], v[132:135]
    v_exp_f32 v147, v147
    ds_read_b64_tr_b16 v[202:203], v18 offset:12288
    v_cvt_pk_bf16_f32 v225, v146, v147
    s_sub_u32 s48, s48, 2
    s_lshl_b32 s48, s48, 14
    v_mfma_f32_16x16x32_bf16 v[128:131], v[168:171], v[104:107], v[128:131]
    v_exp_f32 v148, v148
    ds_read_b64_tr_b16 v[204:205], v19 offset:8192
    ds_read_b64_tr_b16 v[206:207], v19 offset:12288
    v_mfma_f32_16x16x32_bf16 v[132:135], v[184:187], v[104:107], v[132:135]
    v_exp_f32 v149, v149
    ds_read_b64_tr_b16 v[208:209], v20 offset:8192
    v_cvt_pk_bf16_f32 v226, v148, v149
    v_mfma_f32_16x16x32_bf16 v[128:131], v[172:175], v[108:111], v[128:131]
    v_exp_f32 v150, v150
    ds_read_b64_tr_b16 v[210:211], v20 offset:12288
    v_exp_f32 v151, v151
    v_mfma_f32_16x16x32_bf16 v[132:135], v[188:191], v[108:111], v[132:135]
    ds_read_b64_tr_b16 v[212:213], v21 offset:8192
    v_cvt_pk_bf16_f32 v227, v150, v151
    ds_read_b64_tr_b16 v[214:215], v21 offset:12288
    s_waitcnt lgkmcnt(4)
    v_mfma_f32_16x16x32_bf16 v[32:35], v[192:195], v[224:227], v[32:35]
    ds_read_b64_tr_b16 v[216:217], v22 offset:8192
    ds_read_b64_tr_b16 v[218:219], v22 offset:12288
    v_mfma_f32_16x16x32_bf16 v[36:39], v[196:199], v[224:227], v[36:39]
    ds_read_b64_tr_b16 v[220:221], v23 offset:8192
    v_mfma_f32_16x16x32_bf16 v[40:43], v[200:203], v[224:227], v[40:43]
    ds_read_b64_tr_b16 v[222:223], v23 offset:12288
    v_mfma_f32_16x16x32_bf16 v[44:47], v[204:207], v[224:227], v[44:47]
    s_waitcnt lgkmcnt(4)
    v_mfma_f32_16x16x32_bf16 v[48:51], v[208:211], v[224:227], v[48:51]
    v_mfma_f32_16x16x32_bf16 v[52:55], v[212:215], v[224:227], v[52:55]
    s_waitcnt lgkmcnt(2)
    v_mfma_f32_16x16x32_bf16 v[56:59], v[216:219], v[224:227], v[56:59]
    s_waitcnt lgkmcnt(0)
    v_mfma_f32_16x16x32_bf16 v[60:63], v[220:223], v[224:227], v[60:63]
    v_mfma_f32_16x16x32_bf16 v[232:235], v[244:247], v[224:227], v[232:235]
    ds_read_b128 v[160:163], v8 offset:8192
    v_max3_f32 v6, v128, v129, v130
    v_max3_f32 v6, v6, v131, v132
    ds_read_b128 v[176:179], v8 offset:12288
    ds_read_b128 v[164:167], v9 offset:8192
    ds_read_b128 v[180:183], v9 offset:12288
    v_max3_f32 v6, v6, v133, v134
    ds_read_b128 v[168:171], v10 offset:8192
    v_max_f32 v6, v6, v135
    ds_read_b128 v[184:187], v10 offset:12288
    ds_read_b128 v[172:175], v11 offset:8192
    ds_read_b128 v[188:191], v11 offset:12288
    v_add_u32 v16, s56, v16
    v_cmp_lt_f32 vcc, s52, v6
    v_add_u32 v17, s56, v17
    v_add_u32 v18, s56, v18
    v_add_u32 v19, s56, v19
    v_add_u32 v20, s56, v20
    v_add_u32 v21, s56, v21
    v_add_u32 v22, s56, v22
    v_add_u32 v23, s56, v23
    v_add_u32 v8, s48, v8
    v_add_u32 v9, s48, v9
    v_add_u32 v10, s48, v10
    v_add_u32 v11, s48, v11
    s_cbranch_vccnz L_rescbs
L_backbs:
    s_sub_u32 s42, s42, 1
    s_cmp_lg_u32 s42, 0
    s_cbranch_scc1 L_atts
    s_waitcnt lgkmcnt(0)
    s_barrier
    v_add_u32 v8, 98304, v12
    v_add_u32 v9, 98304, v13
    v_add_u32 v10, 98304, v14
    v_add_u32 v11, 98304, v15
    v_mfma_f32_16x16x32_bf16 v[144:147], v[160:163], v[96:99], v[24:27]
    v_exp_f32 v128, v128
    ds_read_b64_tr_b16 v[192:193], v16 offset:0
    ds_read_b64_tr_b16 v[194:195], v16 offset:4096
    v_mfma_f32_16x16x32_bf16 v[148:151], v[176:179], v[96:99], v[24:27]
    v_exp_f32 v129, v129
    ds_read_b64_tr_b16 v[196:197], v17 offset:0
    v_cvt_pk_bf16_f32 v224, v128, v129
    v_mfma_f32_16x16x32_bf16 v[144:147], v[164:167], v[100:103], v[144:147]
    v_exp_f32 v130, v130
    ds_read_b64_tr_b16 v[198:199], v17 offset:4096
    ds_read_b64_tr_b16 v[200:201], v18 offset:0
    v_mfma_f32_16x16x32_bf16 v[148:151], v[180:183], v[100:103], v[148:151]
    v_exp_f32 v131, v131
    ds_read_b64_tr_b16 v[202:203], v18 offset:4096
    v_cvt_pk_bf16_f32 v225, v130, v131
    v_mfma_f32_16x16x32_bf16 v[144:147], v[168:171], v[104:107], v[144:147]
    v_exp_f32 v132, v132
    ds_read_b64_tr_b16 v[204:205], v19 offset:0
    ds_read_b64_tr_b16 v[206:207], v19 offset:4096
    v_mfma_f32_16x16x32_bf16 v[148:151], v[184:187], v[104:107], v[148:151]
    v_exp_f32 v133, v133
    ds_read_b64_tr_b16 v[208:209], v20 offset:0
    v_cvt_pk_bf16_f32 v226, v132, v133
    v_mfma_f32_16x16x32_bf16 v[144:147], v[172:175], v[108:111], v[144:147]
    v_exp_f32 v134, v134
    ds_read_b64_tr_b16 v[210:211], v20 offset:4096
    v_exp_f32 v135, v135
    v_mfma_f32_16x16x32_bf16 v[148:151], v[188:191], v[108:111], v[148:151]
    ds_read_b64_tr_b16 v[212:213], v21 offset:0
    v_cvt_pk_bf16_f32 v227, v134, v135
    ds_read_b64_tr_b16 v[214:215], v21 offset:4096
    s_waitcnt lgkmcnt(4)
    v_mfma_f32_16x16x32_bf16 v[32:35], v[192:195], v[224:227], v[32:35]
    ds_read_b64_tr_b16 v[216:217], v22 offset:0
    ds_read_b64_tr_b16 v[218:219], v22 offset:4096
    v_mfma_f32_16x16x32_bf16 v[36:39], v[196:199], v[224:227], v[36:39]
    ds_read_b64_tr_b16 v[220:221], v23 offset:0
    v_mfma_f32_16x16x32_bf16 v[40:43], v[200:203], v[224:227], v[40:43]
    ds_read_b64_tr_b16 v[222:223], v23 offset:4096
    v_mfma_f32_16x16x32_bf16 v[44:47], v[204:207], v[224:227], v[44:47]
    s_waitcnt lgkmcnt(4)
    v_mfma_f32_16x16x32_bf16 v[48:51], v[208:211], v[224:227], v[48:51]
    v_mfma_f32_16x16x32_bf16 v[52:55], v[212:215], v[224:227], v[52:55]
    s_waitcnt lgkmcnt(2)
    v_mfma_f32_16x16x32_bf16 v[56:59], v[216:219], v[224:227], v[56:59]
    s_waitcnt lgkmcnt(0)
    v_mfma_f32_16x16x32_bf16 v[60:63], v[220:223], v[224:227], v[60:63]
    v_mfma_f32_16x16x32_bf16 v[232:235], v[244:247], v[224:227], v[232:235]
    ds_read_b64_tr_b16 v[160:161], v8 offset:0
    ds_read_b64_tr_b16 v[162:163], v8 offset:4096
    v_max3_f32 v6, v144, v145, v146
    v_max3_f32 v6, v6, v147, v148
    ds_read_b64_tr_b16 v[164:165], v9 offset:0
    ds_read_b64_tr_b16 v[166:167], v9 offset:4096
    ds_read_b64_tr_b16 v[168:169], v10 offset:0
    ds_read_b64_tr_b16 v[170:171], v10 offset:4096
    ds_read_b64_tr_b16 v[172:173], v11 offset:0
    ds_read_b64_tr_b16 v[174:175], v11 offset:4096
    v_max3_f32 v6, v6, v149, v150
    ds_read_b64_tr_b16 v[176:177], v8 offset:1024
    ds_read_b64_tr_b16 v[178:179], v8 offset:5120
    v_max_f32 v6, v6, v151
    ds_read_b64_tr_b16 v[180:181], v9 offset:1024
    ds_read_b64_tr_b16 v[182:183], v9 offset:5120
    ds_read_b64_tr_b16 v[184:185], v10 offset:1024
    ds_read_b64_tr_b16 v[186:187], v10 offset:5120
    ds_read_b64_tr_b16 v[188:189], v11 offset:1024
    ds_read_b64_tr_b16 v[190:191], v11 offset:5120
    v_cmp_lt_f32 vcc, s52, v6
    s_nop 0
    s_cbranch_vccnz L_resccs
L_backcs:
    v_exp_f32 v144, v144
    v_exp_f32 v145, v145
    v_exp_f32 v146, v146
    v_exp_f32 v147, v147
    v_exp_f32 v148, v148
    v_exp_f32 v149, v149
    v_exp_f32 v150, v150
    v_exp_f32 v151, v151
    v_cvt_pk_bf16_f32 v224, v144, v145
    v_cvt_pk_bf16_f32 v225, v146, v147
    v_cvt_pk_bf16_f32 v226, v148, v149
    v_cvt_pk_bf16_f32 v227, v150, v151
    s_nop 1
    v_mfma_f32_16x16x32_bf16 v[232:235], v[244:247], v[224:227], v[232:235]
    s_waitcnt vmcnt(0)
    v_readlane_b32 s43, v243, 0
    v_mov_b32 v24, 1
    s_add_u32 s45, s49, 4096
    v_cmp_eq_u32 vcc, s43, v243
    s_nop 0
    s_and_b32 s43, vcc_lo, 15
    s_cmp_eq_u32 s43, 15
    s_cselect_b32 s59, s49, 0x40000000
    s_add_u32 s60, s59, 4096
    v_rcp_f32 v232, v232
    s_nop 0
    v_pk_mul_f32 v[144:145], v[144:145], v[232:233] op_sel_hi:[1,0]
    v_pk_mul_f32 v[146:147], v[146:147], v[232:233] op_sel_hi:[1,0]
    v_pk_mul_f32 v[148:149], v[148:149], v[232:233] op_sel_hi:[1,0]
    v_pk_mul_f32 v[150:151], v[150:151], v[232:233] op_sel_hi:[1,0]
    v_pk_mul_f32 v[32:33], v[32:33], v[232:233] op_sel_hi:[1,0]
    v_pk_mul_f32 v[34:35], v[34:35], v[232:233] op_sel_hi:[1,0]
    v_pk_mul_f32 v[36:37], v[36:37], v[232:233] op_sel_hi:[1,0]
    v_pk_mul_f32 v[38:39], v[38:39], v[232:233] op_sel_hi:[1,0]
    v_pk_mul_f32 v[40:41], v[40:41], v[232:233] op_sel_hi:[1,0]
    v_pk_mul_f32 v[42:43], v[42:43], v[232:233] op_sel_hi:[1,0]
    v_pk_mul_f32 v[44:45], v[44:45], v[232:233] op_sel_hi:[1,0]
    v_pk_mul_f32 v[46:47], v[46:47], v[232:233] op_sel_hi:[1,0]
    v_pk_mul_f32 v[48:49], v[48:49], v[232:233] op_sel_hi:[1,0]
    v_pk_mul_f32 v[50:51], v[50:51], v[232:233] op_sel_hi:[1,0]
    v_pk_mul_f32 v[52:53], v[52:53], v[232:233] op_sel_hi:[1,0]
    v_pk_mul_f32 v[54:55], v[54:55], v[232:233] op_sel_hi:[1,0]
    v_pk_mul_f32 v[56:57], v[56:57], v[232:233] op_sel_hi:[1,0]
    v_pk_mul_f32 v[58:59], v[58:59], v[232:233] op_sel_hi:[1,0]
    v_pk_mul_f32 v[60:61], v[60:61], v[232:233] op_sel_hi:[1,0]
    v_pk_mul_f32 v[62:63], v[62:63], v[232:233] op_sel_hi:[1,0]
    v_cvt_pk_bf16_f32 v224, v144, v145
    v_cvt_pk_bf16_f32 v225, v146, v147
    v_cvt_pk_bf16_f32 v226, v148, v149
    v_cvt_pk_bf16_f32 v227, v150, v151
    s_waitcnt lgkmcnt(0)
    s_barrier
    ds_read_b64_tr_b16 v[192:193], v16 offset:8192
    ds_read_b64_tr_b16 v[194:195], v16 offset:12288
    ds_read_b64_tr_b16 v[196:197], v17 offset:8192
    ds_read_b64_tr_b16 v[198:199], v17 offset:12288
    ds_read_b64_tr_b16 v[200:201], v18 offset:8192
    ds_read_b64_tr_b16 v[202:203], v18 offset:12288
    ds_read_b64_tr_b16 v[204:205], v19 offset:8192
    ds_read_b64_tr_b16 v[206:207], v19 offset:12288
    s_waitcnt lgkmcnt(6)
    v_mfma_f32_16x16x32_bf16 v[32:35], v[192:195], v[224:227], v[32:35]
    ds_read_b64_tr_b16 v[208:209], v20 offset:8192
    ds_read_b64_tr_b16 v[210:211], v20 offset:12288
    ds_read_b64_tr_b16 v[212:213], v21 offset:8192
    ds_read_b64_tr_b16 v[214:215], v21 offset:12288
    s_waitcnt lgkmcnt(8)
    v_mfma_f32_16x16x32_bf16 v[36:39], v[196:199], v[224:227], v[36:39]
    ds_read_b64_tr_b16 v[216:217], v22 offset:8192
    ds_read_b64_tr_b16 v[218:219], v22 offset:12288
    ds_read_b64_tr_b16 v[220:221], v23 offset:8192
    ds_read_b64_tr_b16 v[222:223], v23 offset:12288
    s_waitcnt lgkmcnt(10)
    v_mfma_f32_16x16x32_bf16 v[40:43], v[200:203], v[224:227], v[40:43]
    s_waitcnt lgkmcnt(8)
    v_mfma_f32_16x16x32_bf16 v[44:47], v[204:207], v[224:227], v[44:47]
    v_cvt_pk_bf16_f32 v96, v32, v33
    v_cvt_pk_bf16_f32 v97, v34, v35
    v_cvt_pk_bf16_f32 v98, v36, v37
    v_cvt_pk_bf16_f32 v99, v38, v39
    s_waitcnt lgkmcnt(6)
    v_mfma_f32_16x16x32_bf16 v[48:51], v[208:211], v[224:227], v[48:51]
    s_waitcnt lgkmcnt(4)
    v_mfma_f32_16x16x32_bf16 v[52:55], v[212:215], v[224:227], v[52:55]
    v_cvt_pk_bf16_f32 v100, v40, v41
    v_cvt_pk_bf16_f32 v101, v42, v43
    v_permlane16_swap_b32 v96, v112
    v_cvt_pk_bf16_f32 v102, v44, v45
    v_cvt_pk_bf16_f32 v103, v46, v47
    v_permlane16_swap_b32 v97, v113
    s_waitcnt lgkmcnt(2)
    v_mfma_f32_16x16x32_bf16 v[56:59], v[216:219], v[224:227], v[56:59]
    v_permlane16_swap_b32 v98, v114
    v_permlane16_swap_b32 v99, v115
    s_waitcnt lgkmcnt(0)
    v_mfma_f32_16x16x32_bf16 v[60:63], v[220:223], v[224:227], v[60:63]
    v_cvt_pk_bf16_f32 v104, v48, v49
    v_cvt_pk_bf16_f32 v105, v50, v51
    v_cvt_pk_bf16_f32 v106, v52, v53
    v_cvt_pk_bf16_f32 v107, v54, v55
    buffer_store_dwordx4 v[96:99], v4, s[28:31], s59 offen offset:0
    buffer_store_dwordx4 v[112:115], v4, s[28:31], s59 offen offset:1024
    v_permlane16_swap_b32 v100, v116
    v_permlane16_swap_b32 v101, v117
    v_permlane16_swap_b32 v102, v118
    v_permlane16_swap_b32 v103, v119
    buffer_store_dwordx4 v[100:103], v4, s[28:31], s59 offen offset:2048
    buffer_store_dwordx4 v[116:119], v4, s[28:31], s59 offen offset:3072
    v_permlane16_swap_b32 v104, v120
    v_permlane16_swap_b32 v105, v121
    v_permlane16_swap_b32 v106, v122
    v_permlane16_swap_b32 v107, v123
    v_cvt_pk_bf16_f32 v108, v56, v57
    v_cvt_pk_bf16_f32 v109, v58, v59
    v_cvt_pk_bf16_f32 v110, v60, v61
    v_cvt_pk_bf16_f32 v111, v62, v63
    buffer_store_dwordx4 v[104:107], v4, s[28:31], s60 offen offset:0
    buffer_store_dwordx4 v[120:123], v4, s[28:31], s60 offen offset:1024
    v_permlane16_swap_b32 v108, v124
    v_permlane16_swap_b32 v109, v125
    v_permlane16_swap_b32 v110, v126
    v_permlane16_swap_b32 v111, v127
    buffer_store_dwordx4 v[108:111], v4, s[28:31], s60 offen offset:2048
    buffer_store_dwordx4 v[124:127], v4, s[28:31], s60 offen offset:3072
    s_branch L_join
L_codeend:
L_rescad:
    s_nop 15
    v_max3_f32 v1, v144, v145, v146
    v_max3_f32 v1, v1, v147, v148
    v_max3_f32 v1, v1, v149, v150
    v_max_f32 v1, v1, v151
    v_mov_b32 v2, v1
    s_nop 1
    v_permlane32_swap_b32 v2, v1
    v_max_f32 v1, v2, v1
    v_mov_b32 v2, v1
    s_nop 1
    v_permlane16_swap_b32 v2, v1
    v_max_f32 v1, v2, v1
    v_max_f32 v1, 0, v1
    v_sub_f32 v2, 0, v1
    v_exp_f32 v2, v2
    v_sub_f32 v24, v24, v1
    v_sub_f32 v25, v25, v1
    v_sub_f32 v26, v26, v1
    v_sub_f32 v27, v27, v1
    v_sub_f32 v144, v144, v1
    v_sub_f32 v145, v145, v1
    v_sub_f32 v146, v146, v1
    v_sub_f32 v147, v147, v1
    v_sub_f32 v148, v148, v1
    v_sub_f32 v149, v149, v1
    v_sub_f32 v150, v150, v1
    v_sub_f32 v151, v151, v1
    v_mul_f32 v232, v232, v2
    v_mul_f32 v233, v233, v2
    v_mul_f32 v234, v234, v2
    v_mul_f32 v235, v235, v2
    v_mul_f32 v32, v32, v2
    v_mul_f32 v33, v33, v2
    v_mul_f32 v34, v34, v2
    v_mul_f32 v35, v35, v2
    v_mul_f32 v36, v36, v2
    v_mul_f32 v37, v37, v2
    v_mul_f32 v38, v38, v2
    v_mul_f32 v39, v39, v2
    v_mul_f32 v40, v40, v2
    v_mul_f32 v41, v41, v2
    v_mul_f32 v42, v42, v2
    v_mul_f32 v43, v43, v2
    v_mul_f32 v44, v44, v2
    v_mul_f32 v45, v45, v2
    v_mul_f32 v46, v46, v2
    v_mul_f32 v47, v47, v2
    v_mul_f32 v48, v48, v2
    v_mul_f32 v49, v49, v2
    v_mul_f32 v50, v50, v2
    v_mul_f32 v51, v51, v2
    v_mul_f32 v52, v52, v2
    v_mul_f32 v53, v53, v2
    v_mul_f32 v54, v54, v2
    v_mul_f32 v55, v55, v2
    v_mul_f32 v56, v56, v2
    v_mul_f32 v57, v57, v2
    v_mul_f32 v58, v58, v2
    v_mul_f32 v59, v59, v2
    v_mul_f32 v60, v60, v2
    v_mul_f32 v61, v61, v2
    v_mul_f32 v62, v62, v2
    v_mul_f32 v63, v63, v2
    v_max3_f32 v1, v152, v153, v154
    v_max3_f32 v1, v1, v155, v156
    v_max3_f32 v1, v1, v157, v158
    v_max_f32 v1, v1, v159
    v_mov_b32 v2, v1
    s_nop 1
    v_permlane32_swap_b32 v2, v1
    v_max_f32 v1, v2, v1
    v_mov_b32 v2, v1
    s_nop 1
    v_permlane16_swap_b32 v2, v1
    v_max_f32 v1, v2, v1
    v_max_f32 v1, 0, v1
    v_sub_f32 v2, 0, v1
    v_exp_f32 v2, v2
    v_sub_f32 v28, v28, v1
    v_sub_f32 v29, v29, v1
    v_sub_f32 v30, v30, v1
    v_sub_f32 v31, v31, v1
    v_sub_f32 v152, v152, v1
    v_sub_f32 v153, v153, v1
    v_sub_f32 v154, v154, v1
    v_sub_f32 v155, v155, v1
    v_sub_f32 v156, v156, v1
    v_sub_f32 v157, v157, v1
    v_sub_f32 v158, v158, v1
    v_sub_f32 v159, v159, v1
    v_mul_f32 v236, v236, v2
    v_mul_f32 v237, v237, v2
    v_mul_f32 v238, v238, v2
    v_mul_f32 v239, v239, v2
    v_mul_f32 v64, v64, v2
    v_mul_f32 v65, v65, v2
    v_mul_f32 v66, v66, v2
    v_mul_f32 v67, v67, v2
    v_mul_f32 v68, v68, v2
    v_mul_f32 v69, v69, v2
    v_mul_f32 v70, v70, v2
    v_mul_f32 v71, v71, v2
    v_mul_f32 v72, v72, v2
    v_mul_f32 v73, v73, v2
    v_mul_f32 v74, v74, v2
    v_mul_f32 v75, v75, v2
    v_mul_f32 v76, v76, v2
    v_mul_f32 v77, v77, v2
    v_mul_f32 v78, v78, v2
    v_mul_f32 v79, v79, v2
    v_mul_f32 v80, v80, v2
    v_mul_f32 v81, v81, v2
    v_mul_f32 v82, v82, v2
    v_mul_f32 v83, v83, v2
    v_mul_f32 v84, v84, v2
    v_mul_f32 v85, v85, v2
    v_mul_f32 v86, v86, v2
    v_mul_f32 v87, v87, v2
    v_mul_f32 v88, v88, v2
    v_mul_f32 v89, v89, v2
    v_mul_f32 v90, v90, v2
    v_mul_f32 v91, v91, v2
    v_mul_f32 v92, v92, v2
    v_mul_f32 v93, v93, v2
    v_mul_f32 v94, v94, v2
    v_mul_f32 v95, v95, v2
    s_nop 1
    s_branch L_backad
L_rescbd:
    s_nop 15
    v_max3_f32 v1, v128, v129, v130
    v_max3_f32 v1, v1, v131, v132
    v_max3_f32 v1, v1, v133, v134
    v_max_f32 v1, v1, v135
    v_mov_b32 v2, v1
    s_nop 1
    v_permlane32_swap_b32 v2, v1
    v_max_f32 v1, v2, v1
    v_mov_b32 v2, v1
    s_nop 1
    v_permlane16_swap_b32 v2, v1
    v_max_f32 v1, v2, v1
    v_max_f32 v1, 0, v1
    v_sub_f32 v2, 0, v1
    v_exp_f32 v2, v2
    v_sub_f32 v24, v24, v1
    v_sub_f32 v25, v25, v1
    v_sub_f32 v26, v26, v1
    v_sub_f32 v27, v27, v1
    v_sub_f32 v128, v128, v1
    v_sub_f32 v129, v129, v1
    v_sub_f32 v130, v130, v1
    v_sub_f32 v131, v131, v1
    v_sub_f32 v132, v132, v1
    v_sub_f32 v133, v133, v1
    v_sub_f32 v134, v134, v1
    v_sub_f32 v135, v135, v1
    v_mul_f32 v232, v232, v2
    v_mul_f32 v233, v233, v2
    v_mul_f32 v234, v234, v2
    v_mul_f32 v235, v235, v2
    v_mul_f32 v32, v32, v2
    v_mul_f32 v33, v33, v2
    v_mul_f32 v34, v34, v2
    v_mul_f32 v35, v35, v2
    v_mul_f32 v36, v36, v2
    v_mul_f32 v37, v37, v2
    v_mul_f32 v38, v38, v2
    v_mul_f32 v39, v39, v2
    v_mul_f32 v40, v40, v2
    v_mul_f32 v41, v41, v2
    v_mul_f32 v42, v42, v2
    v_mul_f32 v43, v43, v2
    v_mul_f32 v44, v44, v2
    v_mul_f32 v45, v45, v2
    v_mul_f32 v46, v46, v2
    v_mul_f32 v47, v47, v2
    v_mul_f32 v48, v48, v2
    v_mul_f32 v49, v49, v2
    v_mul_f32 v50, v50, v2
    v_mul_f32 v51, v51, v2
    v_mul_f32 v52, v52, v2
    v_mul_f32 v53, v53, v2
    v_mul_f32 v54, v54, v2
    v_mul_f32 v55, v55, v2
    v_mul_f32 v56, v56, v2
    v_mul_f32 v57, v57, v2
    v_mul_f32 v58, v58, v2
    v_mul_f32 v59, v59, v2
    v_mul_f32 v60, v60, v2
    v_mul_f32 v61, v61, v2
    v_mul_f32 v62, v62, v2
    v_mul_f32 v63, v63, v2
    v_max3_f32 v1, v136, v137, v138
    v_max3_f32 v1, v1, v139, v140
    v_max3_f32 v1, v1, v141, v142
    v_max_f32 v1, v1, v143
    v_mov_b32 v2, v1
    s_nop 1
    v_permlane32_swap_b32 v2, v1
    v_max_f32 v1, v2, v1
    v_mov_b32 v2, v1
    s_nop 1
    v_permlane16_swap_b32 v2, v1
    v_max_f32 v1, v2, v1
    v_max_f32 v1, 0, v1
    v_sub_f32 v2, 0, v1
    v_exp_f32 v2, v2
    v_sub_f32 v28, v28, v1
    v_sub_f32 v29, v29, v1
    v_sub_f32 v30, v30, v1
    v_sub_f32 v31, v31, v1
    v_sub_f32 v136, v136, v1
    v_sub_f32 v137, v137, v1
    v_sub_f32 v138, v138, v1
    v_sub_f32 v139, v139, v1
    v_sub_f32 v140, v140, v1
    v_sub_f32 v141, v141, v1
    v_sub_f32 v142, v142, v1
    v_sub_f32 v143, v143, v1
    v_mul_f32 v236, v236, v2
    v_mul_f32 v237, v237, v2
    v_mul_f32 v238, v238, v2
    v_mul_f32 v239, v239, v2
    v_mul_f32 v64, v64, v2
    v_mul_f32 v65, v65, v2
    v_mul_f32 v66, v66, v2
    v_mul_f32 v67, v67, v2
    v_mul_f32 v68, v68, v2
    v_mul_f32 v69, v69, v2
    v_mul_f32 v70, v70, v2
    v_mul_f32 v71, v71, v2
    v_mul_f32 v72, v72, v2
    v_mul_f32 v73, v73, v2
    v_mul_f32 v74, v74, v2
    v_mul_f32 v75, v75, v2
    v_mul_f32 v76, v76, v2
    v_mul_f32 v77, v77, v2
    v_mul_f32 v78, v78, v2
    v_mul_f32 v79, v79, v2
    v_mul_f32 v80, v80, v2
    v_mul_f32 v81, v81, v2
    v_mul_f32 v82, v82, v2
    v_mul_f32 v83, v83, v2
    v_mul_f32 v84, v84, v2
    v_mul_f32 v85, v85, v2
    v_mul_f32 v86, v86, v2
    v_mul_f32 v87, v87, v2
    v_mul_f32 v88, v88, v2
    v_mul_f32 v89, v89, v2
    v_mul_f32 v90, v90, v2
    v_mul_f32 v91, v91, v2
    v_mul_f32 v92, v92, v2
    v_mul_f32 v93, v93, v2
    v_mul_f32 v94, v94, v2
    v_mul_f32 v95, v95, v2
    s_nop 1
    s_branch L_backbd
L_resccd:
    s_nop 15
    v_max3_f32 v1, v144, v145, v146
    v_max3_f32 v1, v1, v147, v148
    v_max3_f32 v1, v1, v149, v150
    v_max_f32 v1, v1, v151
    v_mov_b32 v2, v1
    s_nop 1
    v_permlane32_swap_b32 v2, v1
    v_max_f32 v1, v2, v1
    v_mov_b32 v2, v1
    s_nop 1
    v_permlane16_swap_b32 v2, v1
    v_max_f32 v1, v2, v1
    v_max_f32 v1, 0, v1
    v_sub_f32 v2, 0, v1
    v_exp_f32 v2, v2
    v_sub_f32 v24, v24, v1
    v_sub_f32 v25, v25, v1
    v_sub_f32 v26, v26, v1
    v_sub_f32 v27, v27, v1
    v_sub_f32 v144, v144, v1
    v_sub_f32 v145, v145, v1
    v_sub_f32 v146, v146, v1
    v_sub_f32 v147, v147, v1
    v_sub_f32 v148, v148, v1
    v_sub_f32 v149, v149, v1
    v_sub_f32 v150, v150, v1
    v_sub_f32 v151, v151, v1
    v_mul_f32 v232, v232, v2
    v_mul_f32 v233, v233, v2
    v_mul_f32 v234, v234, v2
    v_mul_f32 v235, v235, v2
    v_mul_f32 v32, v32, v2
    v_mul_f32 v33, v33, v2
    v_mul_f32 v34, v34, v2
    v_mul_f32 v35, v35, v2
    v_mul_f32 v36, v36, v2
    v_mul_f32 v37, v37, v2
    v_mul_f32 v38, v38, v2
    v_mul_f32 v39, v39, v2
    v_mul_f32 v40, v40, v2
    v_mul_f32 v41, v41, v2
    v_mul_f32 v42, v42, v2
    v_mul_f32 v43, v43, v2
    v_mul_f32 v44, v44, v2
    v_mul_f32 v45, v45, v2
    v_mul_f32 v46, v46, v2
    v_mul_f32 v47, v47, v2
    v_mul_f32 v48, v48, v2
    v_mul_f32 v49, v49, v2
    v_mul_f32 v50, v50, v2
    v_mul_f32 v51, v51, v2
    v_mul_f32 v52, v52, v2
    v_mul_f32 v53, v53, v2
    v_mul_f32 v54, v54, v2
    v_mul_f32 v55, v55, v2
    v_mul_f32 v56, v56, v2
    v_mul_f32 v57, v57, v2
    v_mul_f32 v58, v58, v2
    v_mul_f32 v59, v59, v2
    v_mul_f32 v60, v60, v2
    v_mul_f32 v61, v61, v2
    v_mul_f32 v62, v62, v2
    v_mul_f32 v63, v63, v2
    v_max3_f32 v1, v152, v153, v154
    v_max3_f32 v1, v1, v155, v156
    v_max3_f32 v1, v1, v157, v158
    v_max_f32 v1, v1, v159
    v_mov_b32 v2, v1
    s_nop 1
    v_permlane32_swap_b32 v2, v1
    v_max_f32 v1, v2, v1
    v_mov_b32 v2, v1
    s_nop 1
    v_permlane16_swap_b32 v2, v1
    v_max_f32 v1, v2, v1
    v_max_f32 v1, 0, v1
    v_sub_f32 v2, 0, v1
    v_exp_f32 v2, v2
    v_sub_f32 v28, v28, v1
    v_sub_f32 v29, v29, v1
    v_sub_f32 v30, v30, v1
    v_sub_f32 v31, v31, v1
    v_sub_f32 v152, v152, v1
    v_sub_f32 v153, v153, v1
    v_sub_f32 v154, v154, v1
    v_sub_f32 v155, v155, v1
    v_sub_f32 v156, v156, v1
    v_sub_f32 v157, v157, v1
    v_sub_f32 v158, v158, v1
    v_sub_f32 v159, v159, v1
    v_mul_f32 v236, v236, v2
    v_mul_f32 v237, v237, v2
    v_mul_f32 v238, v238, v2
    v_mul_f32 v239, v239, v2
    v_mul_f32 v64, v64, v2
    v_mul_f32 v65, v65, v2
    v_mul_f32 v66, v66, v2
    v_mul_f32 v67, v67, v2
    v_mul_f32 v68, v68, v2
    v_mul_f32 v69, v69, v2
    v_mul_f32 v70, v70, v2
    v_mul_f32 v71, v71, v2
    v_mul_f32 v72, v72, v2
    v_mul_f32 v73, v73, v2
    v_mul_f32 v74, v74, v2
    v_mul_f32 v75, v75, v2
    v_mul_f32 v76, v76, v2
    v_mul_f32 v77, v77, v2
    v_mul_f32 v78, v78, v2
    v_mul_f32 v79, v79, v2
    v_mul_f32 v80, v80, v2
    v_mul_f32 v81, v81, v2
    v_mul_f32 v82, v82, v2
    v_mul_f32 v83, v83, v2
    v_mul_f32 v84, v84, v2
    v_mul_f32 v85, v85, v2
    v_mul_f32 v86, v86, v2
    v_mul_f32 v87, v87, v2
    v_mul_f32 v88, v88, v2
    v_mul_f32 v89, v89, v2
    v_mul_f32 v90, v90, v2
    v_mul_f32 v91, v91, v2
    v_mul_f32 v92, v92, v2
    v_mul_f32 v93, v93, v2
    v_mul_f32 v94, v94, v2
    v_mul_f32 v95, v95, v2
    s_nop 1
    s_branch L_backcd
L_rescas:
    s_nop 15
    v_max3_f32 v1, v144, v145, v146
    v_max3_f32 v1, v1, v147, v148
    v_max3_f32 v1, v1, v149, v150
    v_max_f32 v1, v1, v151
    v_mov_b32 v2, v1
    s_nop 1
    v_permlane32_swap_b32 v2, v1
    v_max_f32 v1, v2, v1
    v_mov_b32 v2, v1
    s_nop 1
    v_permlane16_swap_b32 v2, v1
    v_max_f32 v1, v2, v1
    v_max_f32 v1, 0, v1
    v_sub_f32 v2, 0, v1
    v_exp_f32 v2, v2
    v_sub_f32 v24, v24, v1
    v_sub_f32 v25, v25, v1
    v_sub_f32 v26, v26, v1
    v_sub_f32 v27, v27, v1
    v_sub_f32 v144, v144, v1
    v_sub_f32 v145, v145, v1
    v_sub_f32 v146, v146, v1
    v_sub_f32 v147, v147, v1
    v_sub_f32 v148, v148, v1
    v_sub_f32 v149, v149, v1
    v_sub_f32 v150, v150, v1
    v_sub_f32 v151, v151, v1
    v_mul_f32 v232, v232, v2
    v_mul_f32 v233, v233, v2
    v_mul_f32 v234, v234, v2
    v_mul_f32 v235, v235, v2
    v_mul_f32 v32, v32, v2
    v_mul_f32 v33, v33, v2
    v_mul_f32 v34, v34, v2
    v_mul_f32 v35, v35, v2
    v_mul_f32 v36, v36, v2
    v_mul_f32 v37, v37, v2
    v_mul_f32 v38, v38, v2
    v_mul_f32 v39, v39, v2
    v_mul_f32 v40, v40, v2
    v_mul_f32 v41, v41, v2
    v_mul_f32 v42, v42, v2
    v_mul_f32 v43, v43, v2
    v_mul_f32 v44, v44, v2
    v_mul_f32 v45, v45, v2
    v_mul_f32 v46, v46, v2
    v_mul_f32 v47, v47, v2
    v_mul_f32 v48, v48, v2
    v_mul_f32 v49, v49, v2
    v_mul_f32 v50, v50, v2
    v_mul_f32 v51, v51, v2
    v_mul_f32 v52, v52, v2
    v_mul_f32 v53, v53, v2
    v_mul_f32 v54, v54, v2
    v_mul_f32 v55, v55, v2
    v_mul_f32 v56, v56, v2
    v_mul_f32 v57, v57, v2
    v_mul_f32 v58, v58, v2
    v_mul_f32 v59, v59, v2
    v_mul_f32 v60, v60, v2
    v_mul_f32 v61, v61, v2
    v_mul_f32 v62, v62, v2
    v_mul_f32 v63, v63, v2
    s_nop 1
    s_branch L_backas
L_rescbs:
    s_nop 15
    v_max3_f32 v1, v128, v129, v130
    v_max3_f32 v1, v1, v131, v132
    v_max3_f32 v1, v1, v133, v134
    v_max_f32 v1, v1, v135
    v_mov_b32 v2, v1
    s_nop 1
    v_permlane32_swap_b32 v2, v1
    v_max_f32 v1, v2, v1
    v_mov_b32 v2, v1
    s_nop 1
    v_permlane16_swap_b32 v2, v1
    v_max_f32 v1, v2, v1
    v_max_f32 v1, 0, v1
    v_sub_f32 v2, 0, v1
    v_exp_f32 v2, v2
    v_sub_f32 v24, v24, v1
    v_sub_f32 v25, v25, v1
    v_sub_f32 v26, v26, v1
    v_sub_f32 v27, v27, v1
    v_sub_f32 v128, v128, v1
    v_sub_f32 v129, v129, v1
    v_sub_f32 v130, v130, v1
    v_sub_f32 v131, v131, v1
    v_sub_f32 v132, v132, v1
    v_sub_f32 v133, v133, v1
    v_sub_f32 v134, v134, v1
    v_sub_f32 v135, v135, v1
    v_mul_f32 v232, v232, v2
    v_mul_f32 v233, v233, v2
    v_mul_f32 v234, v234, v2
    v_mul_f32 v235, v235, v2
    v_mul_f32 v32, v32, v2
    v_mul_f32 v33, v33, v2
    v_mul_f32 v34, v34, v2
    v_mul_f32 v35, v35, v2
    v_mul_f32 v36, v36, v2
    v_mul_f32 v37, v37, v2
    v_mul_f32 v38, v38, v2
    v_mul_f32 v39, v39, v2
    v_mul_f32 v40, v40, v2
    v_mul_f32 v41, v41, v2
    v_mul_f32 v42, v42, v2
    v_mul_f32 v43, v43, v2
    v_mul_f32 v44, v44, v2
    v_mul_f32 v45, v45, v2
    v_mul_f32 v46, v46, v2
    v_mul_f32 v47, v47, v2
    v_mul_f32 v48, v48, v2
    v_mul_f32 v49, v49, v2
    v_mul_f32 v50, v50, v2
    v_mul_f32 v51, v51, v2
    v_mul_f32 v52, v52, v2
    v_mul_f32 v53, v53, v2
    v_mul_f32 v54, v54, v2
    v_mul_f32 v55, v55, v2
    v_mul_f32 v56, v56, v2
    v_mul_f32 v57, v57, v2
    v_mul_f32 v58, v58, v2
    v_mul_f32 v59, v59, v2
    v_mul_f32 v60, v60, v2
    v_mul_f32 v61, v61, v2
    v_mul_f32 v62, v62, v2
    v_mul_f32 v63, v63, v2
    s_nop 1
    s_branch L_backbs
L_resccs:
    s_nop 15
    v_max3_f32 v1, v144, v145, v146
    v_max3_f32 v1, v1, v147, v148
    v_max3_f32 v1, v1, v149, v150
    v_max_f32 v1, v1, v151
    v_mov_b32 v2, v1
    s_nop 1
    v_permlane32_swap_b32 v2, v1
    v_max_f32 v1, v2, v1
    v_mov_b32 v2, v1
    s_nop 1
    v_permlane16_swap_b32 v2, v1
    v_max_f32 v1, v2, v1
    v_max_f32 v1, 0, v1
    v_sub_f32 v2, 0, v1
    v_exp_f32 v2, v2
    v_sub_f32 v24, v24, v1
    v_sub_f32 v25, v25, v1
    v_sub_f32 v26, v26, v1
    v_sub_f32 v27, v27, v1
    v_sub_f32 v144, v144, v1
    v_sub_f32 v145, v145, v1
    v_sub_f32 v146, v146, v1
    v_sub_f32 v147, v147, v1
    v_sub_f32 v148, v148, v1
    v_sub_f32 v149, v149, v1
    v_sub_f32 v150, v150, v1
    v_sub_f32 v151, v151, v1
    v_mul_f32 v232, v232, v2
    v_mul_f32 v233, v233, v2
    v_mul_f32 v234, v234, v2
    v_mul_f32 v235, v235, v2
    v_mul_f32 v32, v32, v2
    v_mul_f32 v33, v33, v2
    v_mul_f32 v34, v34, v2
    v_mul_f32 v35, v35, v2
    v_mul_f32 v36, v36, v2
    v_mul_f32 v37, v37, v2
    v_mul_f32 v38, v38, v2
    v_mul_f32 v39, v39, v2
    v_mul_f32 v40, v40, v2
    v_mul_f32 v41, v41, v2
    v_mul_f32 v42, v42, v2
    v_mul_f32 v43, v43, v2
    v_mul_f32 v44, v44, v2
    v_mul_f32 v45, v45, v2
    v_mul_f32 v46, v46, v2
    v_mul_f32 v47, v47, v2
    v_mul_f32 v48, v48, v2
    v_mul_f32 v49, v49, v2
    v_mul_f32 v50, v50, v2
    v_mul_f32 v51, v51, v2
    v_mul_f32 v52, v52, v2
    v_mul_f32 v53, v53, v2
    v_mul_f32 v54, v54, v2
    v_mul_f32 v55, v55, v2
    v_mul_f32 v56, v56, v2
    v_mul_f32 v57, v57, v2
    v_mul_f32 v58, v58, v2
    v_mul_f32 v59, v59, v2
    v_mul_f32 v60, v60, v2
    v_mul_f32 v61, v61, v2
    v_mul_f32 v62, v62, v2
    v_mul_f32 v63, v63, v2
    s_nop 1
    s_branch L_backcs
.p2align 8
.fill 64, 4, 0xbf800000
.section .rodata,"a"
.p2align 6
.amdhsa_kernel standalone__mha_block_cached__near_ridge_kernel
  .amdhsa_next_free_vgpr 256
  .amdhsa_next_free_sgpr 102
  .amdhsa_accum_offset 256
  .amdhsa_group_segment_fixed_size 0
  .amdhsa_kernarg_size 64
  .amdhsa_user_sgpr_count 2
  .amdhsa_user_sgpr_kernarg_segment_ptr 1
  .amdhsa_system_sgpr_workgroup_id_x 1
.end_amdhsa_kernel
```
